```python
import torch

def _softmax(x, axis=-1):
    return torch.softmax(x, dim=axis)
def _gelu(x):
    return torch.nn.functional.gelu(x, approximate="tanh")
def _silu(x):
    return torch.nn.functional.silu(x)
def _sigmoid(x):
    return torch.sigmoid(x)
def _layernorm(x, axis=-1, eps=1e-5):
    m = x.mean(dim=axis, keepdim=True)
    v = x.var(dim=axis, keepdim=True, unbiased=False)
    return (x - m) / torch.sqrt(v + eps)
def _scatter_add(tgt, idx, src, axis=0):
    return tgt.clone().index_add_(axis, idx, src)
def _segment_sum(src, seg, n):
    out = torch.zeros((n,) + src.shape[1:], dtype=src.dtype)
    return out.index_add_(0, seg, src)
def _pad(x, pw):
    flat = tuple(v for pair in reversed(pw) for v in pair)
    return torch.nn.functional.pad(x, flat)

kernel_name = 'parallel_sum__spectral_fnet__dense_activation_relu__prompt'

def setup_inputs():

    _w = (lambda a: (lambda t: t.to(torch.bfloat16) if t.is_floating_point() else t)(torch.as_tensor(a)))
    def _A_setup():
        B, S, D = 1, 2048, 640
        ns = torch.arange(S)[:, None] * torch.arange(S)[None, :]
        nd = torch.arange(D)[:, None] * torch.arange(D)[None, :]
        Ws_re = torch.cos(-2.0 * torch.pi * ns / S).to(float)
        Ws_im = torch.sin(-2.0 * torch.pi * ns / S).to(float)
        Wd_re = torch.cos(-2.0 * torch.pi * nd / D).to(float)
        Wd_im = torch.sin(-2.0 * torch.pi * nd / D).to(float)
        return {
            "x": _w((lambda *s: torch.randn(*s, dtype=torch.bfloat16) * 0.05)(B, S, D)),
            "dft_seq_re": _w(Ws_re),
            "dft_seq_im": _w(Ws_im),
            "dft_hid_re": _w(Wd_re),
            "dft_hid_im": _w(Wd_im),
        }
    _A_in = _A_setup()

    def _B_setup():
        B, S, D, Dff = 1, 2048, 640, 1728
        return {
            "x": _w((lambda *s: torch.randn(*s, dtype=torch.bfloat16) * 0.05)(B, S, D)),
            "w1": _w((lambda *s: torch.randn(*s, dtype=torch.bfloat16) * 0.4)(D, Dff)),
            "w2": _w((lambda *s: torch.randn(*s, dtype=torch.bfloat16) * 0.4)(Dff, D)),
        }
    _B_in = _B_setup()

    return {
        "A_x": _A_in["x"],
        "A_dft_seq_re": _A_in["dft_seq_re"],
        "A_dft_seq_im": _A_in["dft_seq_im"],
        "A_dft_hid_re": _A_in["dft_hid_re"],
        "A_dft_hid_im": _A_in["dft_hid_im"],
        "B_x": _B_in["x"],
        "B_w1": _B_in["w1"],
        "B_w2": _B_in["w2"],
    }

def reference(A_x, A_dft_seq_re, A_dft_seq_im, A_dft_hid_re, A_dft_hid_im, B_x, B_w1, B_w2):
    def _A_ref(x, dft_seq_re, dft_seq_im, dft_hid_re, dft_hid_im):
        a = torch.einsum("bsd,ed->bse", x, dft_hid_re)
        b = torch.einsum("bsd,ed->bse", x, dft_hid_im)
        y = torch.einsum("ts,bse->bte", dft_seq_re, a) - torch.einsum("ts,bse->bte", dft_seq_im, b)
        return y

    def _B_ref(x, w1, w2):
        h = torch.einsum("bsd,df->bsf", x, w1)
        zero = torch.zeros_like(h)
        h = torch.maximum(h, zero)
        return torch.einsum("bsf,fd->bsd", h, w2)

    x = A_x
    xn = _layernorm(x, axis=-1)
    return x + _A_ref(xn, A_dft_seq_re, A_dft_seq_im, A_dft_hid_re, A_dft_hid_im) + _B_ref(xn, B_w1, B_w2)
```

```asm
; @launch grid=(256,1,1) block=(512,1,1) lds=163840
.amdgcn_target "amdgcn-amd-amdhsa--gfx950"
.text
.globl parallel_sum__spectral_fnet__dense_activation_relu__prompt_kernel
.p2align 8
.type parallel_sum__spectral_fnet__dense_activation_relu__prompt_kernel,@function
parallel_sum__spectral_fnet__dense_activation_relu__prompt_kernel:
  s_cmp_ge_u32 s2, 256
  s_cbranch_scc1 L_parallel_sum__spectral_fnet__dense_activation_relu__prompt_kernel_end
  s_load_dwordx2 s[4:5], s[0:1], 0
  s_load_dwordx4 s[8:11], s[0:1], 64
  s_load_dwordx4 s[12:15], s[0:1], 24
  s_load_dwordx4 s[16:19], s[0:1], 48
  s_load_dwordx2 s[20:21], s[0:1], 80
  v_lshrrev_b32 v6, 6, v0
  v_and_b32 v1, 63, v0
  v_readfirstlane_b32 s52, v6
  v_lshrrev_b32 v2, 3, v1
  v_and_b32 v3, 7, v1
  v_and_b32 v4, 15, v1
  v_lshrrev_b32 v5, 4, v1
  s_and_b32 s56, s2, 7
  s_lshr_b32 s57, s2, 3
  s_lshr_b32 s47, s57, 2
  s_lshr_b32 s58, s56, 1
  s_and_b32 s55, s56, 1
  s_lshr_b32 s59, s57, 3
  s_lshl_b32 s58, s58, 2
  s_add_u32 s58, s58, s59
  s_sub_u32 s53, 32, s58
  s_cmp_eq_u32 s58, 0
  s_cselect_b32 s53, 16, s53
  s_bitcmp1_b32 s57, 2
  s_cselect_b32 s53, s53, s58
  s_lshl_b32 s56, s55, 1
  s_bfe_u32 s59, s57, 0x10001
  s_add_u32 s56, s56, s59
  s_sub_u32 s44, 7, s56
  s_and_b32 s45, s57, 1
  s_cmp_eq_u32 s45, 1
  s_cselect_b32 s44, s44, s56
  s_mov_b32 s100, s53
  s_sub_u32 s59, 32, s100
  s_and_b32 s59, s59, 31
  s_cmp_eq_u32 s45, 1
  s_cselect_b32 s46, s59, s100
  s_and_b32 s57, s57, 3
  s_mul_i32 s49, s55, 3
  s_add_u32 s49, s49, s57
  s_mov_b32 s56, 0x000F0500
  s_cmp_eq_u32 s55, 0
  s_cselect_b32 s56, s56, 0x0017130A
  s_lshl_b32 s58, s57, 3
  s_lshr_b32 s56, s56, s58
  s_and_b32 s54, s56, 0xff
  s_cmp_lt_u32 s54, 15
  s_cselect_b32 s64, 0, 1
  s_cmp_eq_u32 s57, 3
  s_cselect_b32 s64, 2, s64
  s_and_b32 s63, s52, 3
  s_cmp_ge_u32 s52, 4
  s_cbranch_scc1 L_prod
  s_lshl_b32 s56, s52, 4
  v_add_u32 v128, s56, v2
  v_and_b32 v7, 31, v128
  v_lshlrev_b32 v7, 6, v7
  v_lshrrev_b32 v8, 5, v128
  v_lshlrev_b32 v8, 5, v8
  v_add3_u32 v7, v7, v8, s53
  v_mul_u32_u24 v7, 1280, v7
  v_lshlrev_b32 v8, 4, v3
  v_add_u32 v14, v7, v8
  s_mov_b32 s56, 655360
  s_mov_b32 s67, 0x3acccccd
  s_mov_b32 s68, 0x3727c5ac
  s_mov_b32 s69, 0x3f803f80
  s_waitcnt lgkmcnt(0)
  s_mov_b32 s24, s4
  s_mov_b32 s25, s5
  s_mov_b32 s26, 2621440
  s_mov_b32 s27, 0x00020000
  buffer_load_dwordx4 v[16:19], v14, s[24:27], 0 offen offset:0
  buffer_load_dwordx4 v[20:23], v14, s[24:27], 0 offen offset:128
  buffer_load_dwordx4 v[24:27], v14, s[24:27], 0 offen offset:256
  buffer_load_dwordx4 v[28:31], v14, s[24:27], 0 offen offset:384
  buffer_load_dwordx4 v[32:35], v14, s[24:27], 0 offen offset:512
  buffer_load_dwordx4 v[36:39], v14, s[24:27], 0 offen offset:640
  buffer_load_dwordx4 v[40:43], v14, s[24:27], 0 offen offset:768
  buffer_load_dwordx4 v[44:47], v14, s[24:27], 0 offen offset:896
  buffer_load_dwordx4 v[48:51], v14, s[24:27], 0 offen offset:1024
  buffer_load_dwordx4 v[52:55], v14, s[24:27], 0 offen offset:1152
  buffer_load_dwordx4 v[56:59], v14, s[24:27], s56 offen offset:0
  buffer_load_dwordx4 v[60:63], v14, s[24:27], s56 offen offset:128
  buffer_load_dwordx4 v[64:67], v14, s[24:27], s56 offen offset:256
  buffer_load_dwordx4 v[68:71], v14, s[24:27], s56 offen offset:384
  buffer_load_dwordx4 v[72:75], v14, s[24:27], s56 offen offset:512
  buffer_load_dwordx4 v[76:79], v14, s[24:27], s56 offen offset:640
  buffer_load_dwordx4 v[80:83], v14, s[24:27], s56 offen offset:768
  buffer_load_dwordx4 v[84:87], v14, s[24:27], s56 offen offset:896
  buffer_load_dwordx4 v[88:91], v14, s[24:27], s56 offen offset:1024
  buffer_load_dwordx4 v[92:95], v14, s[24:27], s56 offen offset:1152
  s_cmp_eq_u32 s64, 2
  s_cbranch_scc1 L_F_cons
  s_cmp_eq_u32 s64, 1
  s_cbranch_scc1 L_N_cons
  s_branch L_W_cons
L_prod:
  s_waitcnt lgkmcnt(0)
  s_mov_b32 s92, s10
  s_mov_b32 s93, s11
  s_mov_b32 s94, 256
  s_mov_b32 s95, 0x00020000
  s_add_u32 s96, s20, 20971520
  s_addc_u32 s97, s21, 0
  s_mov_b32 s98, 262144
  s_mov_b32 s99, 0x00020000
  s_cmp_lg_u32 s2, 0
  s_cbranch_scc1 L_no_pub
  s_cmp_lg_u32 s52, 4
  s_cbranch_scc1 L_no_pub
  s_memrealtime s[50:51]
  s_waitcnt lgkmcnt(0)
  s_or_b32 s50, s50, 1
  v_mov_b32 v7, s50
  v_mov_b32 v6, 0
  s_mov_b64 exec, 1
  buffer_store_dword v7, v6, s[92:95], 0 offen sc1
  s_mov_b64 exec, -1
L_no_pub:
  s_cmp_eq_u32 s64, 2
  s_cbranch_scc1 L_F_prod
  s_cmp_eq_u32 s64, 1
  s_cbranch_scc1 L_N_prod
L_W_prod:
  s_mov_b32 s28, s16
  s_mov_b32 s29, s17
  s_mov_b32 s30, 2211840
  s_mov_b32 s31, 0x00020000
  s_mul_i32 s56, s63, 320
  s_lshl_b32 s57, s54, 7
  s_mul_i32 s60, s63, 5120
  s_add_u32 s60, s60, 81920
  s_mov_b32 s61, 0
  v_add_u32 v7, s56, v1
  v_mul_u32_u24 v8, 1639, v7
  v_lshrrev_b32 v8, 16, v8
  v_mul_u32_u24 v9, 40, v8
  v_sub_u32 v9, v7, v9
  v_bfe_u32 v10, v8, 1, 1
  v_bfe_u32 v11, v8, 3, 1
  v_lshl_or_b32 v10, v11, 1, v10
  v_lshrrev_b32 v11, 1, v9
  v_xor_b32 v11, v11, v10
  v_lshlrev_b32 v11, 5, v11
  v_and_b32 v9, 1, v9
  v_lshl_add_u32 v11, v9, 4, v11
  v_mul_u32_u24 v8, 3456, v8
  v_add3_u32 v160, v8, v11, s57
  s_add_u32 m0, s60, 0
  s_nop 0
  buffer_load_dwordx4 v160, s[28:31], s61 offen lds
  v_add_u32 v7, s56, v1
  v_add_u32 v7, 64, v7
  v_mul_u32_u24 v8, 1639, v7
  v_lshrrev_b32 v8, 16, v8
  v_mul_u32_u24 v9, 40, v8
  v_sub_u32 v9, v7, v9
  v_bfe_u32 v10, v8, 1, 1
  v_bfe_u32 v11, v8, 3, 1
  v_lshl_or_b32 v10, v11, 1, v10
  v_lshrrev_b32 v11, 1, v9
  v_xor_b32 v11, v11, v10
  v_lshlrev_b32 v11, 5, v11
  v_and_b32 v9, 1, v9
  v_lshl_add_u32 v11, v9, 4, v11
  v_mul_u32_u24 v8, 3456, v8
  v_add3_u32 v161, v8, v11, s57
  s_add_u32 m0, s60, 1024
  s_nop 0
  buffer_load_dwordx4 v161, s[28:31], s61 offen lds
  v_add_u32 v7, s56, v1
  v_add_u32 v7, 128, v7
  v_mul_u32_u24 v8, 1639, v7
  v_lshrrev_b32 v8, 16, v8
  v_mul_u32_u24 v9, 40, v8
  v_sub_u32 v9, v7, v9
  v_bfe_u32 v10, v8, 1, 1
  v_bfe_u32 v11, v8, 3, 1
  v_lshl_or_b32 v10, v11, 1, v10
  v_lshrrev_b32 v11, 1, v9
  v_xor_b32 v11, v11, v10
  v_lshlrev_b32 v11, 5, v11
  v_and_b32 v9, 1, v9
  v_lshl_add_u32 v11, v9, 4, v11
  v_mul_u32_u24 v8, 3456, v8
  v_add3_u32 v162, v8, v11, s57
  s_add_u32 m0, s60, 2048
  s_nop 0
  buffer_load_dwordx4 v162, s[28:31], s61 offen lds
  v_add_u32 v7, s56, v1
  v_add_u32 v7, 192, v7
  v_mul_u32_u24 v8, 1639, v7
  v_lshrrev_b32 v8, 16, v8
  v_mul_u32_u24 v9, 40, v8
  v_sub_u32 v9, v7, v9
  v_bfe_u32 v10, v8, 1, 1
  v_bfe_u32 v11, v8, 3, 1
  v_lshl_or_b32 v10, v11, 1, v10
  v_lshrrev_b32 v11, 1, v9
  v_xor_b32 v11, v11, v10
  v_lshlrev_b32 v11, 5, v11
  v_and_b32 v9, 1, v9
  v_lshl_add_u32 v11, v9, 4, v11
  v_mul_u32_u24 v8, 3456, v8
  v_add3_u32 v163, v8, v11, s57
  s_add_u32 m0, s60, 3072
  s_nop 0
  buffer_load_dwordx4 v163, s[28:31], s61 offen lds
  v_add_u32 v7, s56, v1
  v_add_u32 v7, 256, v7
  v_mul_u32_u24 v8, 1639, v7
  v_lshrrev_b32 v8, 16, v8
  v_mul_u32_u24 v9, 40, v8
  v_sub_u32 v9, v7, v9
  v_bfe_u32 v10, v8, 1, 1
  v_bfe_u32 v11, v8, 3, 1
  v_lshl_or_b32 v10, v11, 1, v10
  v_lshrrev_b32 v11, 1, v9
  v_xor_b32 v11, v11, v10
  v_lshlrev_b32 v11, 5, v11
  v_and_b32 v9, 1, v9
  v_lshl_add_u32 v11, v9, 4, v11
  v_mul_u32_u24 v8, 3456, v8
  v_add3_u32 v164, v8, v11, s57
  s_add_u32 m0, s60, 4096
  s_nop 0
  buffer_load_dwordx4 v164, s[28:31], s61 offen lds
  s_add_u32 s61, s61, 110592
  s_add_u32 m0, s60, 20480
  s_nop 0
  buffer_load_dwordx4 v160, s[28:31], s61 offen lds
  s_add_u32 m0, s60, 21504
  s_nop 0
  buffer_load_dwordx4 v161, s[28:31], s61 offen lds
  s_add_u32 m0, s60, 22528
  s_nop 0
  buffer_load_dwordx4 v162, s[28:31], s61 offen lds
  s_add_u32 m0, s60, 23552
  s_nop 0
  buffer_load_dwordx4 v163, s[28:31], s61 offen lds
  s_add_u32 m0, s60, 24576
  s_nop 0
  buffer_load_dwordx4 v164, s[28:31], s61 offen lds
  s_add_u32 s61, s61, 110592
  s_add_u32 m0, s60, 40960
  s_nop 0
  buffer_load_dwordx4 v160, s[28:31], s61 offen lds
  s_add_u32 m0, s60, 41984
  s_nop 0
  buffer_load_dwordx4 v161, s[28:31], s61 offen lds
  s_add_u32 m0, s60, 43008
  s_nop 0
  buffer_load_dwordx4 v162, s[28:31], s61 offen lds
  s_add_u32 m0, s60, 44032
  s_nop 0
  buffer_load_dwordx4 v163, s[28:31], s61 offen lds
  s_add_u32 m0, s60, 45056
  s_nop 0
  buffer_load_dwordx4 v164, s[28:31], s61 offen lds
  s_add_u32 s61, s61, 110592
  s_add_u32 m0, s60, 61440
  s_nop 0
  buffer_load_dwordx4 v160, s[28:31], s61 offen lds
  s_add_u32 m0, s60, 62464
  s_nop 0
  buffer_load_dwordx4 v161, s[28:31], s61 offen lds
  s_add_u32 m0, s60, 63488
  s_nop 0
  buffer_load_dwordx4 v162, s[28:31], s61 offen lds
  s_add_u32 m0, s60, 64512
  s_nop 0
  buffer_load_dwordx4 v163, s[28:31], s61 offen lds
  s_add_u32 m0, s60, 65536
  s_nop 0
  buffer_load_dwordx4 v164, s[28:31], s61 offen lds
  s_add_u32 s61, s61, 110592
  s_lshl_b32 s56, s47, 2
  s_add_u32 s56, s56, s63
  s_lshl_b32 s57, s54, 7
  s_add_u32 s57, s57, 442368
  v_lshlrev_b32 v7, 5, v1
  v_add_u32 v7, s56, v7
  v_mul_u32_u24 v8, 52429, v7
  v_lshrrev_b32 v8, 18, v8
  v_mul_u32_u24 v9, 5, v8
  v_sub_u32 v9, v7, v9
  v_mul_u32_u24 v8, 3456, v8
  v_lshl_add_u32 v8, v9, 7, v8
  buffer_load_dword v172, v8, s[28:31], s57 offen
  v_lshlrev_b32 v7, 5, v1
  v_add_u32 v7, s56, v7
  v_add_u32 v7, 2048, v7
  v_mul_u32_u24 v8, 52429, v7
  v_lshrrev_b32 v8, 18, v8
  v_mul_u32_u24 v9, 5, v8
  v_sub_u32 v9, v7, v9
  v_mul_u32_u24 v8, 3456, v8
  v_lshl_add_u32 v8, v9, 7, v8
  buffer_load_dword v173, v8, s[28:31], s57 offen
  s_waitcnt vmcnt(17)
  s_barrier
  s_mov_b32 s62, 16
  s_mov_b32 s56, 0
L_W_ploop:
  s_waitcnt vmcnt(10)
  s_barrier
  s_add_u32 s57, s60, s56
  s_add_u32 m0, s57, 0
  s_nop 0
  buffer_load_dwordx4 v160, s[28:31], s61 offen lds
  s_add_u32 m0, s57, 1024
  s_nop 0
  buffer_load_dwordx4 v161, s[28:31], s61 offen lds
  s_add_u32 m0, s57, 2048
  s_nop 0
  buffer_load_dwordx4 v162, s[28:31], s61 offen lds
  s_add_u32 m0, s57, 3072
  s_nop 0
  buffer_load_dwordx4 v163, s[28:31], s61 offen lds
  s_add_u32 m0, s57, 4096
  s_nop 0
  buffer_load_dwordx4 v164, s[28:31], s61 offen lds
  s_add_u32 s61, s61, 110592
  s_add_u32 s56, s56, 20480
  s_cmp_eq_u32 s56, 81920
  s_cselect_b32 s56, 0, s56
  s_sub_u32 s62, s62, 1
  s_cmp_lg_u32 s62, 0
  s_cbranch_scc1 L_W_ploop
  s_waitcnt vmcnt(10)
  s_barrier
  s_waitcnt vmcnt(5)
  s_barrier
  s_waitcnt vmcnt(0)
  s_barrier
  s_barrier
  v_mov_b32 v6, 0
  buffer_load_dword v130, v6, s[92:95], 0 offen sc1
  s_waitcnt vmcnt(0)
  s_mov_b32 s51, 131072
L_nonce_1:
  v_readfirstlane_b32 s48, v130
  s_nop 3
  s_cmp_lg_u32 s48, 0
  s_cbranch_scc1 L_nonce_ok_2
  s_sub_u32 s51, s51, 1
  s_cmp_eq_u32 s51, 0
  s_cbranch_scc1 L_nonce_ok_2
  s_sleep 1
  v_mov_b32 v6, 0
  buffer_load_dword v130, v6, s[92:95], 0 offen sc1
  s_waitcnt vmcnt(0)
  s_branch L_nonce_1
L_nonce_ok_2:
  s_lshr_b32 s50, s44, 1
  v_lshl_add_u32 v8, v1, 2, s50
  v_lshlrev_b32 v8, 7, v8
  v_add_u32 v8, 163840, v8
  s_mov_b32 s51, 131072
L_poll_3:
  buffer_load_dword v10, v8, s[96:99], 0 offen sc1
  s_waitcnt vmcnt(0)
  v_cmp_ne_u32 vcc, s48, v10
  s_nop 1
  s_mov_b32 s50, vcc_lo
  s_or_b32 s50, s50, vcc_hi
  s_cmp_eq_u32 s50, 0
  s_cbranch_scc1 L_poll_ok_4
  s_sub_u32 s51, s51, 1
  s_cmp_eq_u32 s51, 0
  s_cbranch_scc1 L_poll_ok_4
  s_sleep 1
  s_branch L_poll_3
L_poll_ok_4:
  s_barrier
  s_branch L_K2_dma
L_N_prod:
  s_mov_b32 s28, s16
  s_mov_b32 s29, s17
  s_mov_b32 s30, 2211840
  s_mov_b32 s31, 0x00020000
  s_mul_i32 s56, s63, 256
  s_lshl_b32 s57, s54, 7
  s_mul_i32 s60, s63, 4096
  s_add_u32 s60, s60, 81920
  s_mov_b32 s61, 0
  v_add_u32 v7, s56, v1
  v_lshrrev_b32 v8, 5, v7
  v_mul_u32_u24 v9, 32, v8
  v_sub_u32 v9, v7, v9
  v_and_b32 v10, 3, v8
  v_bfe_u32 v11, v8, 3, 1
  v_lshl_or_b32 v10, v11, 2, v10
  v_lshrrev_b32 v11, 1, v9
  v_xor_b32 v11, v11, v10
  v_lshlrev_b32 v11, 5, v11
  v_and_b32 v9, 1, v9
  v_lshl_add_u32 v11, v9, 4, v11
  v_mul_u32_u24 v8, 3456, v8
  v_add3_u32 v160, v8, v11, s57
  s_add_u32 m0, s60, 0
  s_nop 0
  buffer_load_dwordx4 v160, s[28:31], s61 offen lds
  v_add_u32 v7, s56, v1
  v_add_u32 v7, 64, v7
  v_lshrrev_b32 v8, 5, v7
  v_mul_u32_u24 v9, 32, v8
  v_sub_u32 v9, v7, v9
  v_and_b32 v10, 3, v8
  v_bfe_u32 v11, v8, 3, 1
  v_lshl_or_b32 v10, v11, 2, v10
  v_lshrrev_b32 v11, 1, v9
  v_xor_b32 v11, v11, v10
  v_lshlrev_b32 v11, 5, v11
  v_and_b32 v9, 1, v9
  v_lshl_add_u32 v11, v9, 4, v11
  v_mul_u32_u24 v8, 3456, v8
  v_add3_u32 v161, v8, v11, s57
  s_add_u32 m0, s60, 1024
  s_nop 0
  buffer_load_dwordx4 v161, s[28:31], s61 offen lds
  v_add_u32 v7, s56, v1
  v_add_u32 v7, 128, v7
  v_lshrrev_b32 v8, 5, v7
  v_mul_u32_u24 v9, 32, v8
  v_sub_u32 v9, v7, v9
  v_and_b32 v10, 3, v8
  v_bfe_u32 v11, v8, 3, 1
  v_lshl_or_b32 v10, v11, 2, v10
  v_lshrrev_b32 v11, 1, v9
  v_xor_b32 v11, v11, v10
  v_lshlrev_b32 v11, 5, v11
  v_and_b32 v9, 1, v9
  v_lshl_add_u32 v11, v9, 4, v11
  v_mul_u32_u24 v8, 3456, v8
  v_add3_u32 v162, v8, v11, s57
  s_add_u32 m0, s60, 2048
  s_nop 0
  buffer_load_dwordx4 v162, s[28:31], s61 offen lds
  v_add_u32 v7, s56, v1
  v_add_u32 v7, 192, v7
  v_lshrrev_b32 v8, 5, v7
  v_mul_u32_u24 v9, 32, v8
  v_sub_u32 v9, v7, v9
  v_and_b32 v10, 3, v8
  v_bfe_u32 v11, v8, 3, 1
  v_lshl_or_b32 v10, v11, 2, v10
  v_lshrrev_b32 v11, 1, v9
  v_xor_b32 v11, v11, v10
  v_lshlrev_b32 v11, 5, v11
  v_and_b32 v9, 1, v9
  v_lshl_add_u32 v11, v9, 4, v11
  v_mul_u32_u24 v8, 3456, v8
  v_add3_u32 v163, v8, v11, s57
  s_add_u32 m0, s60, 3072
  s_nop 0
  buffer_load_dwordx4 v163, s[28:31], s61 offen lds
  s_add_u32 s61, s61, 110592
  s_add_u32 m0, s60, 16384
  s_nop 0
  buffer_load_dwordx4 v160, s[28:31], s61 offen lds
  s_add_u32 m0, s60, 17408
  s_nop 0
  buffer_load_dwordx4 v161, s[28:31], s61 offen lds
  s_add_u32 m0, s60, 18432
  s_nop 0
  buffer_load_dwordx4 v162, s[28:31], s61 offen lds
  s_add_u32 m0, s60, 19456
  s_nop 0
  buffer_load_dwordx4 v163, s[28:31], s61 offen lds
  s_add_u32 s61, s61, 110592
  s_add_u32 m0, s60, 32768
  s_nop 0
  buffer_load_dwordx4 v160, s[28:31], s61 offen lds
  s_add_u32 m0, s60, 33792
  s_nop 0
  buffer_load_dwordx4 v161, s[28:31], s61 offen lds
  s_add_u32 m0, s60, 34816
  s_nop 0
  buffer_load_dwordx4 v162, s[28:31], s61 offen lds
  s_add_u32 m0, s60, 35840
  s_nop 0
  buffer_load_dwordx4 v163, s[28:31], s61 offen lds
  s_add_u32 s61, s61, 110592
  s_add_u32 m0, s60, 49152
  s_nop 0
  buffer_load_dwordx4 v160, s[28:31], s61 offen lds
  s_add_u32 m0, s60, 50176
  s_nop 0
  buffer_load_dwordx4 v161, s[28:31], s61 offen lds
  s_add_u32 m0, s60, 51200
  s_nop 0
  buffer_load_dwordx4 v162, s[28:31], s61 offen lds
  s_add_u32 m0, s60, 52224
  s_nop 0
  buffer_load_dwordx4 v163, s[28:31], s61 offen lds
  s_add_u32 s61, s61, 110592
  s_lshl_b32 s56, s47, 2
  s_add_u32 s56, s56, s63
  s_lshl_b32 s57, s54, 7
  s_add_u32 s57, s57, 442368
  v_lshlrev_b32 v7, 5, v1
  v_add_u32 v7, s56, v7
  v_lshrrev_b32 v8, 2, v7
  v_mul_u32_u24 v9, 4, v8
  v_sub_u32 v9, v7, v9
  v_mul_u32_u24 v8, 3456, v8
  v_lshl_add_u32 v8, v9, 7, v8
  buffer_load_dword v172, v8, s[28:31], s57 offen
  v_lshlrev_b32 v7, 5, v1
  v_add_u32 v7, s56, v7
  v_add_u32 v7, 2048, v7
  v_lshrrev_b32 v8, 2, v7
  v_mul_u32_u24 v9, 4, v8
  v_sub_u32 v9, v7, v9
  v_mul_u32_u24 v8, 3456, v8
  v_lshl_add_u32 v8, v9, 7, v8
  buffer_load_dword v173, v8, s[28:31], s57 offen
  s_waitcnt vmcnt(14)
  s_barrier
  s_mov_b32 s62, 16
  s_mov_b32 s56, 0
L_N_ploop:
  s_waitcnt vmcnt(8)
  s_barrier
  s_add_u32 s57, s60, s56
  s_add_u32 m0, s57, 0
  s_nop 0
  buffer_load_dwordx4 v160, s[28:31], s61 offen lds
  s_add_u32 m0, s57, 1024
  s_nop 0
  buffer_load_dwordx4 v161, s[28:31], s61 offen lds
  s_add_u32 m0, s57, 2048
  s_nop 0
  buffer_load_dwordx4 v162, s[28:31], s61 offen lds
  s_add_u32 m0, s57, 3072
  s_nop 0
  buffer_load_dwordx4 v163, s[28:31], s61 offen lds
  s_add_u32 s61, s61, 110592
  s_add_u32 s56, s56, 16384
  s_cmp_eq_u32 s56, 65536
  s_cselect_b32 s56, 0, s56
  s_sub_u32 s62, s62, 1
  s_cmp_lg_u32 s62, 0
  s_cbranch_scc1 L_N_ploop
  s_waitcnt vmcnt(8)
  s_barrier
  s_waitcnt vmcnt(4)
  s_barrier
  s_waitcnt vmcnt(0)
  s_barrier
  s_barrier
  v_mov_b32 v6, 0
  buffer_load_dword v130, v6, s[92:95], 0 offen sc1
  s_waitcnt vmcnt(0)
  s_mov_b32 s51, 131072
L_nonce_5:
  v_readfirstlane_b32 s48, v130
  s_nop 3
  s_cmp_lg_u32 s48, 0
  s_cbranch_scc1 L_nonce_ok_6
  s_sub_u32 s51, s51, 1
  s_cmp_eq_u32 s51, 0
  s_cbranch_scc1 L_nonce_ok_6
  s_sleep 1
  v_mov_b32 v6, 0
  buffer_load_dword v130, v6, s[92:95], 0 offen sc1
  s_waitcnt vmcnt(0)
  s_branch L_nonce_5
L_nonce_ok_6:
  s_lshr_b32 s50, s44, 1
  v_lshl_add_u32 v8, v1, 2, s50
  v_lshlrev_b32 v8, 7, v8
  v_add_u32 v8, 163840, v8
  s_mov_b32 s51, 131072
L_poll_7:
  buffer_load_dword v10, v8, s[96:99], 0 offen sc1
  s_waitcnt vmcnt(0)
  v_cmp_ne_u32 vcc, s48, v10
  s_nop 1
  s_mov_b32 s50, vcc_lo
  s_or_b32 s50, s50, vcc_hi
  s_cmp_eq_u32 s50, 0
  s_cbranch_scc1 L_poll_ok_8
  s_sub_u32 s51, s51, 1
  s_cmp_eq_u32 s51, 0
  s_cbranch_scc1 L_poll_ok_8
  s_sleep 1
  s_branch L_poll_7
L_poll_ok_8:
  s_barrier
  s_branch L_K2_dma
L_F_prod:
  s_cmp_ge_u32 s63, 2
  s_cselect_b32 s28, s14, s12
  s_cselect_b32 s29, s15, s13
  s_mov_b32 s30, 819200
  s_mov_b32 s31, 0x00020000
  s_add_u32 s32, s20, 12582912
  s_addc_u32 s33, s21, 0
  s_mov_b32 s34, 2621440
  s_mov_b32 s35, 0x00020000
  s_mov_b32 s36, s18
  s_mov_b32 s37, s19
  s_mov_b32 s38, 2211840
  s_mov_b32 s39, 0x00020000
  s_add_u32 s40, s20, 8388608
  s_addc_u32 s41, s21, 0
  s_mov_b32 s42, 2211840
  s_mov_b32 s43, 0x00020000
  s_lshl_b32 s65, s53, 1
  s_add_u32 s65, s65, s55
  s_sub_u32 s56, 2, s55
  s_and_b32 s57, s63, 1
  s_lshl_b32 s57, s57, 4
  s_add_u32 s56, s56, s57
  v_lshl_add_u32 v7, v2, 1, s56
  v_mul_u32_u24 v7, 1280, v7
  s_lshl_b32 s57, s63, 2
  v_add_u32 v8, s57, v5
  v_and_b32 v8, 7, v8
  v_xor_b32 v8, v8, v3
  v_lshl_add_u32 v160, v8, 4, v7
  s_lshl_b32 s60, s63, 10
  s_add_u32 s60, s60, 40960
  s_mul_i32 s56, s65, 40960
  s_mul_i32 s57, s63, 320
  s_add_u32 s56, s56, s57
  s_cmp_lt_u32 s65, 54
  s_cselect_b32 s58, s56, 2147418112
  s_mul_i32 s57, s63, 10240
  s_add_u32 s57, s57, 122880
  v_add_u32 v7, 0, v1
  v_mul_u32_u24 v8, 3277, v7
  v_lshrrev_b32 v8, 16, v8
  v_mul_u32_u24 v9, 20, v8
  v_sub_u32 v9, v7, v9
  v_mul_u32_u24 v8, 1280, v8
  v_lshl_add_u32 v8, v9, 4, v8
  s_add_u32 m0, s57, 0
  s_nop 0
  buffer_load_dwordx4 v8, s[36:39], s58 offen lds
  v_add_u32 v7, 64, v1
  v_mul_u32_u24 v8, 3277, v7
  v_lshrrev_b32 v8, 16, v8
  v_mul_u32_u24 v9, 20, v8
  v_sub_u32 v9, v7, v9
  v_mul_u32_u24 v8, 1280, v8
  v_lshl_add_u32 v8, v9, 4, v8
  s_add_u32 m0, s57, 1024
  s_nop 0
  buffer_load_dwordx4 v8, s[36:39], s58 offen lds
  v_add_u32 v7, 128, v1
  v_mul_u32_u24 v8, 3277, v7
  v_lshrrev_b32 v8, 16, v8
  v_mul_u32_u24 v9, 20, v8
  v_sub_u32 v9, v7, v9
  v_mul_u32_u24 v8, 1280, v8
  v_lshl_add_u32 v8, v9, 4, v8
  s_add_u32 m0, s57, 2048
  s_nop 0
  buffer_load_dwordx4 v8, s[36:39], s58 offen lds
  v_add_u32 v7, 192, v1
  v_mul_u32_u24 v8, 3277, v7
  v_lshrrev_b32 v8, 16, v8
  v_mul_u32_u24 v9, 20, v8
  v_sub_u32 v9, v7, v9
  v_mul_u32_u24 v8, 1280, v8
  v_lshl_add_u32 v8, v9, 4, v8
  s_add_u32 m0, s57, 3072
  s_nop 0
  buffer_load_dwordx4 v8, s[36:39], s58 offen lds
  v_add_u32 v7, 256, v1
  v_mul_u32_u24 v8, 3277, v7
  v_lshrrev_b32 v8, 16, v8
  v_mul_u32_u24 v9, 20, v8
  v_sub_u32 v9, v7, v9
  v_mul_u32_u24 v8, 1280, v8
  v_lshl_add_u32 v8, v9, 4, v8
  s_add_u32 m0, s57, 4096
  s_nop 0
  buffer_load_dwordx4 v8, s[36:39], s58 offen lds
  v_add_u32 v7, 320, v1
  v_mul_u32_u24 v8, 3277, v7
  v_lshrrev_b32 v8, 16, v8
  v_mul_u32_u24 v9, 20, v8
  v_sub_u32 v9, v7, v9
  v_mul_u32_u24 v8, 1280, v8
  v_lshl_add_u32 v8, v9, 4, v8
  s_add_u32 m0, s57, 5120
  s_nop 0
  buffer_load_dwordx4 v8, s[36:39], s58 offen lds
  v_add_u32 v7, 384, v1
  v_mul_u32_u24 v8, 3277, v7
  v_lshrrev_b32 v8, 16, v8
  v_mul_u32_u24 v9, 20, v8
  v_sub_u32 v9, v7, v9
  v_mul_u32_u24 v8, 1280, v8
  v_lshl_add_u32 v8, v9, 4, v8
  s_add_u32 m0, s57, 6144
  s_nop 0
  buffer_load_dwordx4 v8, s[36:39], s58 offen lds
  v_add_u32 v7, 448, v1
  v_mul_u32_u24 v8, 3277, v7
  v_lshrrev_b32 v8, 16, v8
  v_mul_u32_u24 v9, 20, v8
  v_sub_u32 v9, v7, v9
  v_mul_u32_u24 v8, 1280, v8
  v_lshl_add_u32 v8, v9, 4, v8
  s_add_u32 m0, s57, 7168
  s_nop 0
  buffer_load_dwordx4 v8, s[36:39], s58 offen lds
  v_add_u32 v7, 512, v1
  v_mul_u32_u24 v8, 3277, v7
  v_lshrrev_b32 v8, 16, v8
  v_mul_u32_u24 v9, 20, v8
  v_sub_u32 v9, v7, v9
  v_mul_u32_u24 v8, 1280, v8
  v_lshl_add_u32 v8, v9, 4, v8
  s_add_u32 m0, s57, 8192
  s_nop 0
  buffer_load_dwordx4 v8, s[36:39], s58 offen lds
  v_add_u32 v7, 576, v1
  v_mul_u32_u24 v8, 3277, v7
  v_lshrrev_b32 v8, 16, v8
  v_mul_u32_u24 v9, 20, v8
  v_sub_u32 v9, v7, v9
  v_mul_u32_u24 v8, 1280, v8
  v_lshl_add_u32 v8, v9, 4, v8
  s_add_u32 m0, s57, 9216
  s_nop 0
  buffer_load_dwordx4 v8, s[36:39], s58 offen lds
  s_add_u32 m0, s60, 0
  s_mov_b32 s61, 0
  buffer_load_dwordx4 v160, s[28:31], s61 offen lds
  s_add_u32 m0, s60, 4096
  s_mov_b32 s61, 40960
  buffer_load_dwordx4 v160, s[28:31], s61 offen lds
  s_add_u32 m0, s60, 8192
  s_mov_b32 s61, 81920
  buffer_load_dwordx4 v160, s[28:31], s61 offen lds
  s_add_u32 m0, s60, 12288
  s_mov_b32 s61, 122880
  buffer_load_dwordx4 v160, s[28:31], s61 offen lds
  s_add_u32 m0, s60, 16384
  s_mov_b32 s61, 163840
  buffer_load_dwordx4 v160, s[28:31], s61 offen lds
  s_add_u32 m0, s60, 20480
  s_mov_b32 s61, 204800
  buffer_load_dwordx4 v160, s[28:31], s61 offen lds
  s_add_u32 m0, s60, 24576
  s_mov_b32 s61, 245760
  buffer_load_dwordx4 v160, s[28:31], s61 offen lds
  s_add_u32 m0, s60, 28672
  s_mov_b32 s61, 286720
  buffer_load_dwordx4 v160, s[28:31], s61 offen lds
  s_add_u32 m0, s60, 32768
  s_mov_b32 s61, 327680
  buffer_load_dwordx4 v160, s[28:31], s61 offen lds
  s_add_u32 m0, s60, 36864
  s_mov_b32 s61, 368640
  buffer_load_dwordx4 v160, s[28:31], s61 offen lds
  s_add_u32 m0, s60, 40960
  s_mov_b32 s61, 128
  buffer_load_dwordx4 v160, s[28:31], s61 offen lds
  s_add_u32 m0, s60, 45056
  s_mov_b32 s61, 41088
  buffer_load_dwordx4 v160, s[28:31], s61 offen lds
  s_add_u32 m0, s60, 49152
  s_mov_b32 s61, 82048
  buffer_load_dwordx4 v160, s[28:31], s61 offen lds
  s_add_u32 m0, s60, 53248
  s_mov_b32 s61, 123008
  buffer_load_dwordx4 v160, s[28:31], s61 offen lds
  s_add_u32 m0, s60, 57344
  s_mov_b32 s61, 163968
  buffer_load_dwordx4 v160, s[28:31], s61 offen lds
  s_add_u32 m0, s60, 61440
  s_mov_b32 s61, 204928
  buffer_load_dwordx4 v160, s[28:31], s61 offen lds
  s_add_u32 m0, s60, 65536
  s_mov_b32 s61, 245888
  buffer_load_dwordx4 v160, s[28:31], s61 offen lds
  s_add_u32 m0, s60, 69632
  s_mov_b32 s61, 286848
  buffer_load_dwordx4 v160, s[28:31], s61 offen lds
  s_add_u32 m0, s60, 73728
  s_mov_b32 s61, 327808
  buffer_load_dwordx4 v160, s[28:31], s61 offen lds
  s_add_u32 m0, s60, 77824
  s_mov_b32 s61, 368768
  buffer_load_dwordx4 v160, s[28:31], s61 offen lds
  s_lshl_b32 s56, s47, 1
  s_and_b32 s57, s63, 1
  s_add_u32 s56, s56, s57
  v_lshlrev_b32 v7, 4, v1
  v_add_u32 v7, s56, v7
  v_mul_u32_u24 v8, 6554, v7
  v_lshrrev_b32 v8, 20, v8
  v_mul_u32_u24 v9, 160, v8
  v_sub_u32 v9, v7, v9
  s_sub_u32 s57, 2, s55
  v_lshl_add_u32 v9, v9, 1, s57
  v_mul_u32_u24 v9, 1280, v9
  v_lshl_add_u32 v9, v8, 7, v9
  v_add_u32 v9, 256, v9
  v_mov_b32 v7, 2147418112
  v_cmp_gt_u32 vcc, 3, v8
  s_nop 1
  v_cndmask_b32 v9, v7, v9, vcc
  buffer_load_dword v172, v9, s[28:31], 0 offen
  v_bfe_u32 v7, v1, 2, 2
  v_and_b32 v8, 3, v1
  v_lshl_add_u32 v9, v5, 2, v7
  v_mul_u32_u24 v9, 320, v9
  v_lshl_add_u32 v9, v8, 3, v9
  s_mul_i32 s57, s63, 10240
  s_add_u32 s57, s57, 122880
  v_add_u32 v9, s57, v9
  s_waitcnt vmcnt(21)
  ds_read_b64_tr_b16 v[16:17], v9 offset:0
  ds_read_b64_tr_b16 v[18:19], v9 offset:5120
  ds_read_b64_tr_b16 v[20:21], v9 offset:32
  ds_read_b64_tr_b16 v[22:23], v9 offset:5152
  ds_read_b64_tr_b16 v[24:25], v9 offset:64
  ds_read_b64_tr_b16 v[26:27], v9 offset:5184
  ds_read_b64_tr_b16 v[28:29], v9 offset:96
  ds_read_b64_tr_b16 v[30:31], v9 offset:5216
  ds_read_b64_tr_b16 v[32:33], v9 offset:128
  ds_read_b64_tr_b16 v[34:35], v9 offset:5248
  ds_read_b64_tr_b16 v[36:37], v9 offset:160
  ds_read_b64_tr_b16 v[38:39], v9 offset:5280
  ds_read_b64_tr_b16 v[40:41], v9 offset:192
  ds_read_b64_tr_b16 v[42:43], v9 offset:5312
  s_waitcnt lgkmcnt(0)
  ds_read_b64_tr_b16 v[44:45], v9 offset:224
  ds_read_b64_tr_b16 v[46:47], v9 offset:5344
  ds_read_b64_tr_b16 v[48:49], v9 offset:256
  ds_read_b64_tr_b16 v[50:51], v9 offset:5376
  ds_read_b64_tr_b16 v[52:53], v9 offset:288
  ds_read_b64_tr_b16 v[54:55], v9 offset:5408
  v_lshlrev_b32 v6, 4, v1
  s_lshl_b32 s56, s63, 1
  s_mul_i32 s56, s56, 54
  s_add_u32 s56, s56, s65
  s_mul_i32 s56, s56, 5120
  s_cmp_lt_u32 s65, 54
  s_cselect_b32 s56, s56, 2147418112
  s_waitcnt lgkmcnt(0)
  s_add_u32 s57, s56, 0
  buffer_store_dwordx4 v[16:19], v6, s[40:43], s57 offen sc1
  s_add_u32 s57, s56, 1024
  buffer_store_dwordx4 v[20:23], v6, s[40:43], s57 offen sc1
  s_add_u32 s57, s56, 2048
  buffer_store_dwordx4 v[24:27], v6, s[40:43], s57 offen sc1
  s_add_u32 s57, s56, 3072
  buffer_store_dwordx4 v[28:31], v6, s[40:43], s57 offen sc1
  s_add_u32 s57, s56, 4096
  buffer_store_dwordx4 v[32:35], v6, s[40:43], s57 offen sc1
  s_add_u32 s57, s56, 276480
  buffer_store_dwordx4 v[36:39], v6, s[40:43], s57 offen sc1
  s_add_u32 s57, s56, 277504
  buffer_store_dwordx4 v[40:43], v6, s[40:43], s57 offen sc1
  s_add_u32 s57, s56, 278528
  buffer_store_dwordx4 v[44:47], v6, s[40:43], s57 offen sc1
  s_add_u32 s57, s56, 279552
  buffer_store_dwordx4 v[48:51], v6, s[40:43], s57 offen sc1
  s_add_u32 s57, s56, 280576
  buffer_store_dwordx4 v[52:55], v6, s[40:43], s57 offen sc1
  v_mov_b32 v6, 0
  buffer_load_dword v130, v6, s[92:95], 0 offen sc1
  s_waitcnt vmcnt(0)
  s_mov_b32 s51, 131072
L_nonce_9:
  v_readfirstlane_b32 s48, v130
  s_nop 3
  s_cmp_lg_u32 s48, 0
  s_cbranch_scc1 L_nonce_ok_10
  s_sub_u32 s51, s51, 1
  s_cmp_eq_u32 s51, 0
  s_cbranch_scc1 L_nonce_ok_10
  s_sleep 1
  v_mov_b32 v6, 0
  buffer_load_dword v130, v6, s[92:95], 0 offen sc1
  s_waitcnt vmcnt(0)
  s_branch L_nonce_9
L_nonce_ok_10:
  s_lshl_b32 s50, s65, 2
  s_add_u32 s50, s50, s63
  s_lshl_b32 s50, s50, 7
  s_add_u32 s50, s50, 163840
  v_mov_b32 v6, s50
  v_mov_b32 v7, s48
  s_mov_b64 exec, 1
  buffer_store_dword v7, v6, s[96:99], 0 offen sc1
  s_mov_b64 exec, -1
  s_barrier
  s_add_u32 m0, s60, 81920
  s_mov_b32 s61, 256
  buffer_load_dwordx4 v160, s[28:31], s61 offen lds
  s_add_u32 m0, s60, 86016
  s_mov_b32 s61, 41216
  buffer_load_dwordx4 v160, s[28:31], s61 offen lds
  s_add_u32 m0, s60, 90112
  s_mov_b32 s61, 82176
  buffer_load_dwordx4 v160, s[28:31], s61 offen lds
  s_add_u32 m0, s60, 94208
  s_mov_b32 s61, 123136
  buffer_load_dwordx4 v160, s[28:31], s61 offen lds
  s_add_u32 m0, s60, 98304
  s_mov_b32 s61, 164096
  buffer_load_dwordx4 v160, s[28:31], s61 offen lds
  s_add_u32 m0, s60, 102400
  s_mov_b32 s61, 205056
  buffer_load_dwordx4 v160, s[28:31], s61 offen lds
  s_add_u32 m0, s60, 106496
  s_mov_b32 s61, 246016
  buffer_load_dwordx4 v160, s[28:31], s61 offen lds
  s_add_u32 m0, s60, 110592
  s_mov_b32 s61, 286976
  buffer_load_dwordx4 v160, s[28:31], s61 offen lds
  s_add_u32 m0, s60, 114688
  s_mov_b32 s61, 327936
  buffer_load_dwordx4 v160, s[28:31], s61 offen lds
  s_add_u32 m0, s60, 118784
  s_mov_b32 s61, 368896
  buffer_load_dwordx4 v160, s[28:31], s61 offen lds
  s_waitcnt vmcnt(20)
  s_barrier
  s_add_u32 m0, s60, 0
  s_mov_b32 s61, 384
  buffer_load_dwordx4 v160, s[28:31], s61 offen lds
  s_add_u32 m0, s60, 4096
  s_mov_b32 s61, 41344
  buffer_load_dwordx4 v160, s[28:31], s61 offen lds
  s_add_u32 m0, s60, 8192
  s_mov_b32 s61, 82304
  buffer_load_dwordx4 v160, s[28:31], s61 offen lds
  s_add_u32 m0, s60, 12288
  s_mov_b32 s61, 123264
  buffer_load_dwordx4 v160, s[28:31], s61 offen lds
  s_add_u32 m0, s60, 16384
  s_mov_b32 s61, 164224
  buffer_load_dwordx4 v160, s[28:31], s61 offen lds
  s_add_u32 m0, s60, 20480
  s_mov_b32 s61, 205184
  buffer_load_dwordx4 v160, s[28:31], s61 offen lds
  s_add_u32 m0, s60, 24576
  s_mov_b32 s61, 246144
  buffer_load_dwordx4 v160, s[28:31], s61 offen lds
  s_add_u32 m0, s60, 28672
  s_mov_b32 s61, 287104
  buffer_load_dwordx4 v160, s[28:31], s61 offen lds
  s_add_u32 m0, s60, 32768
  s_mov_b32 s61, 328064
  buffer_load_dwordx4 v160, s[28:31], s61 offen lds
  s_add_u32 m0, s60, 36864
  s_mov_b32 s61, 369024
  buffer_load_dwordx4 v160, s[28:31], s61 offen lds
  s_waitcnt vmcnt(10)
  s_barrier
  s_add_u32 m0, s60, 40960
  s_mov_b32 s61, 512
  buffer_load_dwordx4 v160, s[28:31], s61 offen lds
  s_add_u32 m0, s60, 45056
  s_mov_b32 s61, 41472
  buffer_load_dwordx4 v160, s[28:31], s61 offen lds
  s_add_u32 m0, s60, 49152
  s_mov_b32 s61, 82432
  buffer_load_dwordx4 v160, s[28:31], s61 offen lds
  s_add_u32 m0, s60, 53248
  s_mov_b32 s61, 123392
  buffer_load_dwordx4 v160, s[28:31], s61 offen lds
  s_add_u32 m0, s60, 57344
  s_mov_b32 s61, 164352
  buffer_load_dwordx4 v160, s[28:31], s61 offen lds
  s_add_u32 m0, s60, 61440
  s_mov_b32 s61, 205312
  buffer_load_dwordx4 v160, s[28:31], s61 offen lds
  s_add_u32 m0, s60, 65536
  s_mov_b32 s61, 246272
  buffer_load_dwordx4 v160, s[28:31], s61 offen lds
  s_add_u32 m0, s60, 69632
  s_mov_b32 s61, 287232
  buffer_load_dwordx4 v160, s[28:31], s61 offen lds
  s_add_u32 m0, s60, 73728
  s_mov_b32 s61, 328192
  buffer_load_dwordx4 v160, s[28:31], s61 offen lds
  s_add_u32 m0, s60, 77824
  s_mov_b32 s61, 369152
  buffer_load_dwordx4 v160, s[28:31], s61 offen lds
  s_waitcnt vmcnt(10)
  s_barrier
  s_waitcnt vmcnt(0)
  s_barrier
  s_barrier
  s_lshr_b32 s50, s44, 1
  v_lshl_add_u32 v8, v1, 2, s50
  v_lshlrev_b32 v8, 7, v8
  v_add_u32 v8, 163840, v8
  s_mov_b32 s51, 131072
L_poll_11:
  buffer_load_dword v10, v8, s[96:99], 0 offen sc1
  s_waitcnt vmcnt(0)
  v_cmp_ne_u32 vcc, s48, v10
  s_nop 1
  s_mov_b32 s50, vcc_lo
  s_or_b32 s50, s50, vcc_hi
  s_cmp_eq_u32 s50, 0
  s_cbranch_scc1 L_poll_ok_12
  s_sub_u32 s51, s51, 1
  s_cmp_eq_u32 s51, 0
  s_cbranch_scc1 L_poll_ok_12
  s_sleep 1
  s_branch L_poll_11
L_poll_ok_12:
  s_add_u32 s40, s20, 8388608
  s_addc_u32 s41, s21, 0
  s_mov_b32 s42, 2211840
  s_mov_b32 s43, 0x00020000
  s_mul_i32 s56, s63, 14
  s_cmp_eq_u32 s63, 3
  s_cselect_b32 s57, 1, 0
  s_sub_u32 s56, s56, s57
  s_mul_i32 s57, s44, 54
  s_add_u32 s57, s57, s56
  s_mul_i32 s61, s57, 5120
  s_mul_i32 s62, s63, 5120
  v_lshlrev_b32 v11, 4, v1
  s_add_u32 m0, s62, 0
  s_add_u32 s56, s61, 0
  buffer_load_dwordx4 v11, s[40:43], s56 offen sc1 lds
  s_add_u32 m0, s62, 1024
  s_add_u32 s56, s61, 1024
  buffer_load_dwordx4 v11, s[40:43], s56 offen sc1 lds
  s_add_u32 m0, s62, 2048
  s_add_u32 s56, s61, 2048
  buffer_load_dwordx4 v11, s[40:43], s56 offen sc1 lds
  s_add_u32 m0, s62, 3072
  s_add_u32 s56, s61, 3072
  buffer_load_dwordx4 v11, s[40:43], s56 offen sc1 lds
  s_add_u32 m0, s62, 4096
  s_add_u32 s56, s61, 4096
  buffer_load_dwordx4 v11, s[40:43], s56 offen sc1 lds
  s_add_u32 m0, s62, 20480
  s_add_u32 s56, s61, 5120
  buffer_load_dwordx4 v11, s[40:43], s56 offen sc1 lds
  s_add_u32 m0, s62, 21504
  s_add_u32 s56, s61, 6144
  buffer_load_dwordx4 v11, s[40:43], s56 offen sc1 lds
  s_add_u32 m0, s62, 22528
  s_add_u32 s56, s61, 7168
  buffer_load_dwordx4 v11, s[40:43], s56 offen sc1 lds
  s_add_u32 m0, s62, 23552
  s_add_u32 s56, s61, 8192
  buffer_load_dwordx4 v11, s[40:43], s56 offen sc1 lds
  s_add_u32 m0, s62, 24576
  s_add_u32 s56, s61, 9216
  buffer_load_dwordx4 v11, s[40:43], s56 offen sc1 lds
  s_add_u32 m0, s62, 40960
  s_add_u32 s56, s61, 10240
  buffer_load_dwordx4 v11, s[40:43], s56 offen sc1 lds
  s_add_u32 m0, s62, 41984
  s_add_u32 s56, s61, 11264
  buffer_load_dwordx4 v11, s[40:43], s56 offen sc1 lds
  s_add_u32 m0, s62, 43008
  s_add_u32 s56, s61, 12288
  buffer_load_dwordx4 v11, s[40:43], s56 offen sc1 lds
  s_add_u32 m0, s62, 44032
  s_add_u32 s56, s61, 13312
  buffer_load_dwordx4 v11, s[40:43], s56 offen sc1 lds
  s_add_u32 m0, s62, 45056
  s_add_u32 s56, s61, 14336
  buffer_load_dwordx4 v11, s[40:43], s56 offen sc1 lds
  s_add_u32 m0, s62, 61440
  s_add_u32 s56, s61, 15360
  buffer_load_dwordx4 v11, s[40:43], s56 offen sc1 lds
  s_add_u32 m0, s62, 62464
  s_add_u32 s56, s61, 16384
  buffer_load_dwordx4 v11, s[40:43], s56 offen sc1 lds
  s_add_u32 m0, s62, 63488
  s_add_u32 s56, s61, 17408
  buffer_load_dwordx4 v11, s[40:43], s56 offen sc1 lds
  s_add_u32 m0, s62, 64512
  s_add_u32 s56, s61, 18432
  buffer_load_dwordx4 v11, s[40:43], s56 offen sc1 lds
  s_add_u32 m0, s62, 65536
  s_add_u32 s56, s61, 19456
  buffer_load_dwordx4 v11, s[40:43], s56 offen sc1 lds
  s_add_u32 m0, s62, 81920
  s_add_u32 s56, s61, 20480
  buffer_load_dwordx4 v11, s[40:43], s56 offen sc1 lds
  s_add_u32 m0, s62, 82944
  s_add_u32 s56, s61, 21504
  buffer_load_dwordx4 v11, s[40:43], s56 offen sc1 lds
  s_add_u32 m0, s62, 83968
  s_add_u32 s56, s61, 22528
  buffer_load_dwordx4 v11, s[40:43], s56 offen sc1 lds
  s_add_u32 m0, s62, 84992
  s_add_u32 s56, s61, 23552
  buffer_load_dwordx4 v11, s[40:43], s56 offen sc1 lds
  s_add_u32 m0, s62, 86016
  s_add_u32 s56, s61, 24576
  buffer_load_dwordx4 v11, s[40:43], s56 offen sc1 lds
  s_add_u32 m0, s62, 102400
  s_add_u32 s56, s61, 25600
  buffer_load_dwordx4 v11, s[40:43], s56 offen sc1 lds
  s_add_u32 m0, s62, 103424
  s_add_u32 s56, s61, 26624
  buffer_load_dwordx4 v11, s[40:43], s56 offen sc1 lds
  s_add_u32 m0, s62, 104448
  s_add_u32 s56, s61, 27648
  buffer_load_dwordx4 v11, s[40:43], s56 offen sc1 lds
  s_add_u32 m0, s62, 105472
  s_add_u32 s56, s61, 28672
  buffer_load_dwordx4 v11, s[40:43], s56 offen sc1 lds
  s_add_u32 m0, s62, 106496
  s_add_u32 s56, s61, 29696
  buffer_load_dwordx4 v11, s[40:43], s56 offen sc1 lds
  s_branch L_F_copy
L_W_cons:
  s_add_u32 s32, s20, 0
  s_addc_u32 s33, s21, 0
  s_mov_b32 s34, 7077888
  s_mov_b32 s35, 0x00020000
  v_add_u32 v7, 0, v5
  v_xor_b32 v7, v7, v4
  v_lshlrev_b32 v7, 4, v7
  v_mul_u32_u24 v8, 1280, v4
  v_add_u32 v160, v7, v8
  s_and_b32 s56, s52, 1
  s_mul_i32 s56, s56, 40960
  s_sub_u32 s57, 40960, s56
  v_add_u32 v170, s57, v160
  v_add_u32 v160, s56, v160
  v_add_u32 v7, 4, v5
  v_xor_b32 v7, v7, v4
  v_lshlrev_b32 v7, 4, v7
  v_mul_u32_u24 v8, 1280, v4
  v_add_u32 v161, v7, v8
  s_and_b32 s56, s52, 1
  s_mul_i32 s56, s56, 40960
  s_sub_u32 s57, 40960, s56
  v_add_u32 v171, s57, v161
  v_add_u32 v161, s56, v161
  v_add_u32 v7, 8, v5
  v_xor_b32 v7, v7, v4
  v_lshlrev_b32 v7, 4, v7
  v_mul_u32_u24 v8, 1280, v4
  v_add_u32 v162, v7, v8
  s_and_b32 s56, s52, 1
  s_mul_i32 s56, s56, 40960
  s_sub_u32 s57, 40960, s56
  v_add_u32 v172, s57, v162
  v_add_u32 v162, s56, v162
  v_add_u32 v7, 12, v5
  v_xor_b32 v7, v7, v4
  v_lshlrev_b32 v7, 4, v7
  v_mul_u32_u24 v8, 1280, v4
  v_add_u32 v163, v7, v8
  s_and_b32 s56, s52, 1
  s_mul_i32 s56, s56, 40960
  s_sub_u32 s57, 40960, s56
  v_add_u32 v173, s57, v163
  v_add_u32 v163, s56, v163
  v_bfe_u32 v7, v1, 2, 2
  v_and_b32 v8, 3, v1
  v_lshl_add_u32 v9, v5, 3, v7
  v_mul_u32_u24 v9, 640, v9
  v_lshl_add_u32 v9, v8, 3, v9
  v_add_u32 v9, 81920, v9
  v_and_b32 v10, 1, v5
  v_lshrrev_b32 v11, 1, v7
  v_lshl_or_b32 v10, v10, 1, v11
  s_lshl_b32 s57, s52, 2
  s_add_u32 s57, s57, 0
  v_xor_b32 v11, s57, v10
  v_lshl_add_u32 v164, v11, 5, v9
  s_lshl_b32 s57, s52, 2
  s_add_u32 s57, s57, 1
  v_xor_b32 v11, s57, v10
  v_lshl_add_u32 v165, v11, 5, v9
  s_lshl_b32 s57, s52, 2
  s_add_u32 s57, s57, 2
  v_xor_b32 v11, s57, v10
  v_lshl_add_u32 v166, v11, 5, v9
  s_lshl_b32 s57, s52, 2
  s_add_u32 s57, s57, 3
  v_xor_b32 v11, s57, v10
  v_lshl_add_u32 v167, v11, 5, v9
  s_lshr_b32 s57, s52, 1
  s_lshl_b32 s57, s57, 1
  s_add_u32 s57, s57, 16
  v_xor_b32 v11, s57, v10
  v_lshl_add_u32 v168, v11, 5, v9
  s_lshr_b32 s57, s52, 1
  s_lshl_b32 s57, s57, 1
  s_add_u32 s57, s57, 17
  v_xor_b32 v11, s57, v10
  v_lshl_add_u32 v169, v11, 5, v9
  v_mov_b32 v176, 0
  v_mov_b32 v177, 0
  v_mov_b32 v178, 0
  v_mov_b32 v179, 0
  v_mov_b32 v180, 0
  v_mov_b32 v181, 0
  v_mov_b32 v182, 0
  v_mov_b32 v183, 0
  v_mov_b32 v184, 0
  v_mov_b32 v185, 0
  v_mov_b32 v186, 0
  v_mov_b32 v187, 0
  v_mov_b32 v188, 0
  v_mov_b32 v189, 0
  v_mov_b32 v190, 0
  v_mov_b32 v191, 0
  v_mov_b32 v192, 0
  v_mov_b32 v193, 0
  v_mov_b32 v194, 0
  v_mov_b32 v195, 0
  v_mov_b32 v196, 0
  v_mov_b32 v197, 0
  v_mov_b32 v198, 0
  v_mov_b32 v199, 0
  v_mov_b32 v200, 0
  v_mov_b32 v201, 0
  v_mov_b32 v202, 0
  v_mov_b32 v203, 0
  v_mov_b32 v204, 0
  v_mov_b32 v205, 0
  v_mov_b32 v206, 0
  v_mov_b32 v207, 0
  v_mov_b32 v208, 0
  v_mov_b32 v209, 0
  v_mov_b32 v210, 0
  v_mov_b32 v211, 0
  v_mov_b32 v212, 0
  v_mov_b32 v213, 0
  v_mov_b32 v214, 0
  v_mov_b32 v215, 0
  v_mov_b32 v216, 0
  v_mov_b32 v217, 0
  v_mov_b32 v218, 0
  v_mov_b32 v219, 0
  v_mov_b32 v220, 0
  v_mov_b32 v221, 0
  v_mov_b32 v222, 0
  v_mov_b32 v223, 0
  v_mov_b32 v224, 0
  v_mov_b32 v225, 0
  v_mov_b32 v226, 0
  v_mov_b32 v227, 0
  v_mov_b32 v228, 0
  v_mov_b32 v229, 0
  v_mov_b32 v230, 0
  v_mov_b32 v231, 0
  v_mov_b32 v232, 0
  v_mov_b32 v233, 0
  v_mov_b32 v234, 0
  v_mov_b32 v235, 0
  v_mov_b32 v236, 0
  v_mov_b32 v237, 0
  v_mov_b32 v238, 0
  v_mov_b32 v239, 0
  v_mov_b32 v240, 0
  v_mov_b32 v241, 0
  v_mov_b32 v242, 0
  v_mov_b32 v243, 0
  v_mov_b32 v244, 0
  v_mov_b32 v245, 0
  v_mov_b32 v246, 0
  v_mov_b32 v247, 0
  v_mov_b32 v248, 0
  v_mov_b32 v249, 0
  v_mov_b32 v250, 0
  v_mov_b32 v251, 0
  v_mov_b32 v252, 0
  v_mov_b32 v253, 0
  v_mov_b32 v254, 0
  v_mov_b32 v255, 0
  s_waitcnt vmcnt(10)
  v_dot2_f32_bf16 v112, v16, s69, 0
  v_dot2_f32_bf16 v116, v16, v16, 0
  v_dot2_f32_bf16 v113, v17, s69, 0
  v_dot2_f32_bf16 v117, v17, v17, 0
  v_dot2_f32_bf16 v112, v18, s69, v112
  v_dot2_f32_bf16 v116, v18, v18, v116
  v_dot2_f32_bf16 v113, v19, s69, v113
  v_dot2_f32_bf16 v117, v19, v19, v117
  v_dot2_f32_bf16 v112, v20, s69, v112
  v_dot2_f32_bf16 v116, v20, v20, v116
  v_dot2_f32_bf16 v113, v21, s69, v113
  v_dot2_f32_bf16 v117, v21, v21, v117
  v_dot2_f32_bf16 v112, v22, s69, v112
  v_dot2_f32_bf16 v116, v22, v22, v116
  v_dot2_f32_bf16 v113, v23, s69, v113
  v_dot2_f32_bf16 v117, v23, v23, v117
  v_dot2_f32_bf16 v112, v24, s69, v112
  v_dot2_f32_bf16 v116, v24, v24, v116
  v_dot2_f32_bf16 v113, v25, s69, v113
  v_dot2_f32_bf16 v117, v25, v25, v117
  v_dot2_f32_bf16 v112, v26, s69, v112
  v_dot2_f32_bf16 v116, v26, v26, v116
  v_dot2_f32_bf16 v113, v27, s69, v113
  v_dot2_f32_bf16 v117, v27, v27, v117
  v_dot2_f32_bf16 v112, v28, s69, v112
  v_dot2_f32_bf16 v116, v28, v28, v116
  v_dot2_f32_bf16 v113, v29, s69, v113
  v_dot2_f32_bf16 v117, v29, v29, v117
  v_dot2_f32_bf16 v112, v30, s69, v112
  v_dot2_f32_bf16 v116, v30, v30, v116
  v_dot2_f32_bf16 v113, v31, s69, v113
  v_dot2_f32_bf16 v117, v31, v31, v117
  v_dot2_f32_bf16 v112, v32, s69, v112
  v_dot2_f32_bf16 v116, v32, v32, v116
  v_dot2_f32_bf16 v113, v33, s69, v113
  v_dot2_f32_bf16 v117, v33, v33, v117
  v_dot2_f32_bf16 v112, v34, s69, v112
  v_dot2_f32_bf16 v116, v34, v34, v116
  v_dot2_f32_bf16 v113, v35, s69, v113
  v_dot2_f32_bf16 v117, v35, v35, v117
  v_dot2_f32_bf16 v112, v36, s69, v112
  v_dot2_f32_bf16 v116, v36, v36, v116
  v_dot2_f32_bf16 v113, v37, s69, v113
  v_dot2_f32_bf16 v117, v37, v37, v117
  v_dot2_f32_bf16 v112, v38, s69, v112
  v_dot2_f32_bf16 v116, v38, v38, v116
  v_dot2_f32_bf16 v113, v39, s69, v113
  v_dot2_f32_bf16 v117, v39, v39, v117
  v_dot2_f32_bf16 v112, v40, s69, v112
  v_dot2_f32_bf16 v116, v40, v40, v116
  v_dot2_f32_bf16 v113, v41, s69, v113
  v_dot2_f32_bf16 v117, v41, v41, v117
  v_dot2_f32_bf16 v112, v42, s69, v112
  v_dot2_f32_bf16 v116, v42, v42, v116
  v_dot2_f32_bf16 v113, v43, s69, v113
  v_dot2_f32_bf16 v117, v43, v43, v117
  v_dot2_f32_bf16 v112, v44, s69, v112
  v_dot2_f32_bf16 v116, v44, v44, v116
  v_dot2_f32_bf16 v113, v45, s69, v113
  v_dot2_f32_bf16 v117, v45, v45, v117
  v_dot2_f32_bf16 v112, v46, s69, v112
  v_dot2_f32_bf16 v116, v46, v46, v116
  v_dot2_f32_bf16 v113, v47, s69, v113
  v_dot2_f32_bf16 v117, v47, v47, v117
  v_dot2_f32_bf16 v112, v48, s69, v112
  v_dot2_f32_bf16 v116, v48, v48, v116
  v_dot2_f32_bf16 v113, v49, s69, v113
  v_dot2_f32_bf16 v117, v49, v49, v117
  v_dot2_f32_bf16 v112, v50, s69, v112
  v_dot2_f32_bf16 v116, v50, v50, v116
  v_dot2_f32_bf16 v113, v51, s69, v113
  v_dot2_f32_bf16 v117, v51, v51, v117
  v_dot2_f32_bf16 v112, v52, s69, v112
  v_dot2_f32_bf16 v116, v52, v52, v116
  v_dot2_f32_bf16 v113, v53, s69, v113
  v_dot2_f32_bf16 v117, v53, v53, v117
  v_dot2_f32_bf16 v112, v54, s69, v112
  v_dot2_f32_bf16 v116, v54, v54, v116
  v_dot2_f32_bf16 v113, v55, s69, v113
  v_dot2_f32_bf16 v117, v55, v55, v117
  s_nop 2
  v_add_f32 v112, v112, v113
  v_add_f32 v116, v116, v117
  s_nop 0
  v_add_f32_dpp v112, v112, v112 quad_perm:[1,0,3,2] row_mask:0xf bank_mask:0xf
  v_add_f32_dpp v116, v116, v116 quad_perm:[1,0,3,2] row_mask:0xf bank_mask:0xf
  s_nop 0
  v_add_f32_dpp v112, v112, v112 quad_perm:[2,3,0,1] row_mask:0xf bank_mask:0xf
  v_add_f32_dpp v116, v116, v116 quad_perm:[2,3,0,1] row_mask:0xf bank_mask:0xf
  s_nop 0
  v_add_f32_dpp v112, v112, v112 row_half_mirror row_mask:0xf bank_mask:0xf
  v_add_f32_dpp v116, v116, v116 row_half_mirror row_mask:0xf bank_mask:0xf
  s_nop 0
  v_mul_f32 v120, s67, v112
  v_mul_f32 v116, s67, v116
  v_fma_f32 v116, -v120, v120, v116
  v_max_f32 v116, 0, v116
  v_cvt_pk_bf16_f32 v120, v120, v120
  v_cvt_pk_bf16_f32 v116, v116, v116
  v_and_b32 v120, 0xffff0000, v120
  v_and_b32 v116, 0xffff0000, v116
  v_add_f32 v116, s68, v116
  v_cvt_pk_bf16_f32 v116, v116, v116
  v_and_b32 v116, 0xffff0000, v116
  v_sqrt_f32 v116, v116
  s_nop 0
  v_cvt_pk_bf16_f32 v116, v116, v116
  v_and_b32 v116, 0xffff0000, v116
  v_rcp_f32 v122, v116
  s_nop 0
  v_mul_f32 v124, v120, v122
  v_sub_f32 v124, 0, v124
  v_add_u32 v6, 0, v128
  v_and_b32 v7, 15, v6
  v_xor_b32 v8, v3, v7
  v_add_u32 v9, 8, v3
  v_xor_b32 v9, v9, v7
  v_mul_u32_u24 v7, 1280, v6
  v_lshl_add_u32 v14, v8, 4, v7
  v_lshl_add_u32 v15, v9, 4, v7
  v_lshlrev_b32 v96, 16, v16
  v_and_b32 v97, 0xffff0000, v16
  v_lshlrev_b32 v98, 16, v17
  v_and_b32 v99, 0xffff0000, v17
  v_lshlrev_b32 v100, 16, v18
  v_and_b32 v101, 0xffff0000, v18
  v_lshlrev_b32 v102, 16, v19
  v_and_b32 v103, 0xffff0000, v19
  v_pk_fma_f32 v[96:97], v[96:97], v[122:123], v[124:125] op_sel_hi:[1,0,0]
  v_pk_fma_f32 v[98:99], v[98:99], v[122:123], v[124:125] op_sel_hi:[1,0,0]
  v_pk_fma_f32 v[100:101], v[100:101], v[122:123], v[124:125] op_sel_hi:[1,0,0]
  v_pk_fma_f32 v[102:103], v[102:103], v[122:123], v[124:125] op_sel_hi:[1,0,0]
  v_cvt_pk_bf16_f32 v16, v96, v97
  v_cvt_pk_bf16_f32 v17, v98, v99
  v_cvt_pk_bf16_f32 v18, v100, v101
  v_cvt_pk_bf16_f32 v19, v102, v103
  ds_write_b128 v14, v[16:19] offset:0
  v_lshlrev_b32 v104, 16, v20
  v_and_b32 v105, 0xffff0000, v20
  v_lshlrev_b32 v106, 16, v21
  v_and_b32 v107, 0xffff0000, v21
  v_lshlrev_b32 v108, 16, v22
  v_and_b32 v109, 0xffff0000, v22
  v_lshlrev_b32 v110, 16, v23
  v_and_b32 v111, 0xffff0000, v23
  v_pk_fma_f32 v[104:105], v[104:105], v[122:123], v[124:125] op_sel_hi:[1,0,0]
  v_pk_fma_f32 v[106:107], v[106:107], v[122:123], v[124:125] op_sel_hi:[1,0,0]
  v_pk_fma_f32 v[108:109], v[108:109], v[122:123], v[124:125] op_sel_hi:[1,0,0]
  v_pk_fma_f32 v[110:111], v[110:111], v[122:123], v[124:125] op_sel_hi:[1,0,0]
  v_cvt_pk_bf16_f32 v20, v104, v105
  v_cvt_pk_bf16_f32 v21, v106, v107
  v_cvt_pk_bf16_f32 v22, v108, v109
  v_cvt_pk_bf16_f32 v23, v110, v111
  ds_write_b128 v15, v[20:23] offset:0
  v_lshlrev_b32 v96, 16, v24
  v_and_b32 v97, 0xffff0000, v24
  v_lshlrev_b32 v98, 16, v25
  v_and_b32 v99, 0xffff0000, v25
  v_lshlrev_b32 v100, 16, v26
  v_and_b32 v101, 0xffff0000, v26
  v_lshlrev_b32 v102, 16, v27
  v_and_b32 v103, 0xffff0000, v27
  v_pk_fma_f32 v[96:97], v[96:97], v[122:123], v[124:125] op_sel_hi:[1,0,0]
  v_pk_fma_f32 v[98:99], v[98:99], v[122:123], v[124:125] op_sel_hi:[1,0,0]
  v_pk_fma_f32 v[100:101], v[100:101], v[122:123], v[124:125] op_sel_hi:[1,0,0]
  v_pk_fma_f32 v[102:103], v[102:103], v[122:123], v[124:125] op_sel_hi:[1,0,0]
  v_cvt_pk_bf16_f32 v24, v96, v97
  v_cvt_pk_bf16_f32 v25, v98, v99
  v_cvt_pk_bf16_f32 v26, v100, v101
  v_cvt_pk_bf16_f32 v27, v102, v103
  ds_write_b128 v14, v[24:27] offset:256
  v_lshlrev_b32 v104, 16, v28
  v_and_b32 v105, 0xffff0000, v28
  v_lshlrev_b32 v106, 16, v29
  v_and_b32 v107, 0xffff0000, v29
  v_lshlrev_b32 v108, 16, v30
  v_and_b32 v109, 0xffff0000, v30
  v_lshlrev_b32 v110, 16, v31
  v_and_b32 v111, 0xffff0000, v31
  v_pk_fma_f32 v[104:105], v[104:105], v[122:123], v[124:125] op_sel_hi:[1,0,0]
  v_pk_fma_f32 v[106:107], v[106:107], v[122:123], v[124:125] op_sel_hi:[1,0,0]
  v_pk_fma_f32 v[108:109], v[108:109], v[122:123], v[124:125] op_sel_hi:[1,0,0]
  v_pk_fma_f32 v[110:111], v[110:111], v[122:123], v[124:125] op_sel_hi:[1,0,0]
  v_cvt_pk_bf16_f32 v28, v104, v105
  v_cvt_pk_bf16_f32 v29, v106, v107
  v_cvt_pk_bf16_f32 v30, v108, v109
  v_cvt_pk_bf16_f32 v31, v110, v111
  ds_write_b128 v15, v[28:31] offset:256
  v_lshlrev_b32 v96, 16, v32
  v_and_b32 v97, 0xffff0000, v32
  v_lshlrev_b32 v98, 16, v33
  v_and_b32 v99, 0xffff0000, v33
  v_lshlrev_b32 v100, 16, v34
  v_and_b32 v101, 0xffff0000, v34
  v_lshlrev_b32 v102, 16, v35
  v_and_b32 v103, 0xffff0000, v35
  v_pk_fma_f32 v[96:97], v[96:97], v[122:123], v[124:125] op_sel_hi:[1,0,0]
  v_pk_fma_f32 v[98:99], v[98:99], v[122:123], v[124:125] op_sel_hi:[1,0,0]
  v_pk_fma_f32 v[100:101], v[100:101], v[122:123], v[124:125] op_sel_hi:[1,0,0]
  v_pk_fma_f32 v[102:103], v[102:103], v[122:123], v[124:125] op_sel_hi:[1,0,0]
  v_cvt_pk_bf16_f32 v32, v96, v97
  v_cvt_pk_bf16_f32 v33, v98, v99
  v_cvt_pk_bf16_f32 v34, v100, v101
  v_cvt_pk_bf16_f32 v35, v102, v103
  ds_write_b128 v14, v[32:35] offset:512
  v_lshlrev_b32 v104, 16, v36
  v_and_b32 v105, 0xffff0000, v36
  v_lshlrev_b32 v106, 16, v37
  v_and_b32 v107, 0xffff0000, v37
  v_lshlrev_b32 v108, 16, v38
  v_and_b32 v109, 0xffff0000, v38
  v_lshlrev_b32 v110, 16, v39
  v_and_b32 v111, 0xffff0000, v39
  v_pk_fma_f32 v[104:105], v[104:105], v[122:123], v[124:125] op_sel_hi:[1,0,0]
  v_pk_fma_f32 v[106:107], v[106:107], v[122:123], v[124:125] op_sel_hi:[1,0,0]
  v_pk_fma_f32 v[108:109], v[108:109], v[122:123], v[124:125] op_sel_hi:[1,0,0]
  v_pk_fma_f32 v[110:111], v[110:111], v[122:123], v[124:125] op_sel_hi:[1,0,0]
  v_cvt_pk_bf16_f32 v36, v104, v105
  v_cvt_pk_bf16_f32 v37, v106, v107
  v_cvt_pk_bf16_f32 v38, v108, v109
  v_cvt_pk_bf16_f32 v39, v110, v111
  ds_write_b128 v15, v[36:39] offset:512
  v_lshlrev_b32 v96, 16, v40
  v_and_b32 v97, 0xffff0000, v40
  v_lshlrev_b32 v98, 16, v41
  v_and_b32 v99, 0xffff0000, v41
  v_lshlrev_b32 v100, 16, v42
  v_and_b32 v101, 0xffff0000, v42
  v_lshlrev_b32 v102, 16, v43
  v_and_b32 v103, 0xffff0000, v43
  v_pk_fma_f32 v[96:97], v[96:97], v[122:123], v[124:125] op_sel_hi:[1,0,0]
  v_pk_fma_f32 v[98:99], v[98:99], v[122:123], v[124:125] op_sel_hi:[1,0,0]
  v_pk_fma_f32 v[100:101], v[100:101], v[122:123], v[124:125] op_sel_hi:[1,0,0]
  v_pk_fma_f32 v[102:103], v[102:103], v[122:123], v[124:125] op_sel_hi:[1,0,0]
  v_cvt_pk_bf16_f32 v40, v96, v97
  v_cvt_pk_bf16_f32 v41, v98, v99
  v_cvt_pk_bf16_f32 v42, v100, v101
  v_cvt_pk_bf16_f32 v43, v102, v103
  ds_write_b128 v14, v[40:43] offset:768
  v_lshlrev_b32 v104, 16, v44
  v_and_b32 v105, 0xffff0000, v44
  v_lshlrev_b32 v106, 16, v45
  v_and_b32 v107, 0xffff0000, v45
  v_lshlrev_b32 v108, 16, v46
  v_and_b32 v109, 0xffff0000, v46
  v_lshlrev_b32 v110, 16, v47
  v_and_b32 v111, 0xffff0000, v47
  v_pk_fma_f32 v[104:105], v[104:105], v[122:123], v[124:125] op_sel_hi:[1,0,0]
  v_pk_fma_f32 v[106:107], v[106:107], v[122:123], v[124:125] op_sel_hi:[1,0,0]
  v_pk_fma_f32 v[108:109], v[108:109], v[122:123], v[124:125] op_sel_hi:[1,0,0]
  v_pk_fma_f32 v[110:111], v[110:111], v[122:123], v[124:125] op_sel_hi:[1,0,0]
  v_cvt_pk_bf16_f32 v44, v104, v105
  v_cvt_pk_bf16_f32 v45, v106, v107
  v_cvt_pk_bf16_f32 v46, v108, v109
  v_cvt_pk_bf16_f32 v47, v110, v111
  ds_write_b128 v15, v[44:47] offset:768
  v_lshlrev_b32 v96, 16, v48
  v_and_b32 v97, 0xffff0000, v48
  v_lshlrev_b32 v98, 16, v49
  v_and_b32 v99, 0xffff0000, v49
  v_lshlrev_b32 v100, 16, v50
  v_and_b32 v101, 0xffff0000, v50
  v_lshlrev_b32 v102, 16, v51
  v_and_b32 v103, 0xffff0000, v51
  v_pk_fma_f32 v[96:97], v[96:97], v[122:123], v[124:125] op_sel_hi:[1,0,0]
  v_pk_fma_f32 v[98:99], v[98:99], v[122:123], v[124:125] op_sel_hi:[1,0,0]
  v_pk_fma_f32 v[100:101], v[100:101], v[122:123], v[124:125] op_sel_hi:[1,0,0]
  v_pk_fma_f32 v[102:103], v[102:103], v[122:123], v[124:125] op_sel_hi:[1,0,0]
  v_cvt_pk_bf16_f32 v48, v96, v97
  v_cvt_pk_bf16_f32 v49, v98, v99
  v_cvt_pk_bf16_f32 v50, v100, v101
  v_cvt_pk_bf16_f32 v51, v102, v103
  ds_write_b128 v14, v[48:51] offset:1024
  v_lshlrev_b32 v104, 16, v52
  v_and_b32 v105, 0xffff0000, v52
  v_lshlrev_b32 v106, 16, v53
  v_and_b32 v107, 0xffff0000, v53
  v_lshlrev_b32 v108, 16, v54
  v_and_b32 v109, 0xffff0000, v54
  v_lshlrev_b32 v110, 16, v55
  v_and_b32 v111, 0xffff0000, v55
  v_pk_fma_f32 v[104:105], v[104:105], v[122:123], v[124:125] op_sel_hi:[1,0,0]
  v_pk_fma_f32 v[106:107], v[106:107], v[122:123], v[124:125] op_sel_hi:[1,0,0]
  v_pk_fma_f32 v[108:109], v[108:109], v[122:123], v[124:125] op_sel_hi:[1,0,0]
  v_pk_fma_f32 v[110:111], v[110:111], v[122:123], v[124:125] op_sel_hi:[1,0,0]
  v_cvt_pk_bf16_f32 v52, v104, v105
  v_cvt_pk_bf16_f32 v53, v106, v107
  v_cvt_pk_bf16_f32 v54, v108, v109
  v_cvt_pk_bf16_f32 v55, v110, v111
  ds_write_b128 v15, v[52:55] offset:1024
  s_waitcnt vmcnt(0)
  v_dot2_f32_bf16 v112, v56, s69, 0
  v_dot2_f32_bf16 v116, v56, v56, 0
  v_dot2_f32_bf16 v113, v57, s69, 0
  v_dot2_f32_bf16 v117, v57, v57, 0
  v_dot2_f32_bf16 v112, v58, s69, v112
  v_dot2_f32_bf16 v116, v58, v58, v116
  v_dot2_f32_bf16 v113, v59, s69, v113
  v_dot2_f32_bf16 v117, v59, v59, v117
  v_dot2_f32_bf16 v112, v60, s69, v112
  v_dot2_f32_bf16 v116, v60, v60, v116
  v_dot2_f32_bf16 v113, v61, s69, v113
  v_dot2_f32_bf16 v117, v61, v61, v117
  v_dot2_f32_bf16 v112, v62, s69, v112
  v_dot2_f32_bf16 v116, v62, v62, v116
  v_dot2_f32_bf16 v113, v63, s69, v113
  v_dot2_f32_bf16 v117, v63, v63, v117
  v_dot2_f32_bf16 v112, v64, s69, v112
  v_dot2_f32_bf16 v116, v64, v64, v116
  v_dot2_f32_bf16 v113, v65, s69, v113
  v_dot2_f32_bf16 v117, v65, v65, v117
  v_dot2_f32_bf16 v112, v66, s69, v112
  v_dot2_f32_bf16 v116, v66, v66, v116
  v_dot2_f32_bf16 v113, v67, s69, v113
  v_dot2_f32_bf16 v117, v67, v67, v117
  v_dot2_f32_bf16 v112, v68, s69, v112
  v_dot2_f32_bf16 v116, v68, v68, v116
  v_dot2_f32_bf16 v113, v69, s69, v113
  v_dot2_f32_bf16 v117, v69, v69, v117
  v_dot2_f32_bf16 v112, v70, s69, v112
  v_dot2_f32_bf16 v116, v70, v70, v116
  v_dot2_f32_bf16 v113, v71, s69, v113
  v_dot2_f32_bf16 v117, v71, v71, v117
  v_dot2_f32_bf16 v112, v72, s69, v112
  v_dot2_f32_bf16 v116, v72, v72, v116
  v_dot2_f32_bf16 v113, v73, s69, v113
  v_dot2_f32_bf16 v117, v73, v73, v117
  v_dot2_f32_bf16 v112, v74, s69, v112
  v_dot2_f32_bf16 v116, v74, v74, v116
  v_dot2_f32_bf16 v113, v75, s69, v113
  v_dot2_f32_bf16 v117, v75, v75, v117
  v_dot2_f32_bf16 v112, v76, s69, v112
  v_dot2_f32_bf16 v116, v76, v76, v116
  v_dot2_f32_bf16 v113, v77, s69, v113
  v_dot2_f32_bf16 v117, v77, v77, v117
  v_dot2_f32_bf16 v112, v78, s69, v112
  v_dot2_f32_bf16 v116, v78, v78, v116
  v_dot2_f32_bf16 v113, v79, s69, v113
  v_dot2_f32_bf16 v117, v79, v79, v117
  v_dot2_f32_bf16 v112, v80, s69, v112
  v_dot2_f32_bf16 v116, v80, v80, v116
  v_dot2_f32_bf16 v113, v81, s69, v113
  v_dot2_f32_bf16 v117, v81, v81, v117
  v_dot2_f32_bf16 v112, v82, s69, v112
  v_dot2_f32_bf16 v116, v82, v82, v116
  v_dot2_f32_bf16 v113, v83, s69, v113
  v_dot2_f32_bf16 v117, v83, v83, v117
  v_dot2_f32_bf16 v112, v84, s69, v112
  v_dot2_f32_bf16 v116, v84, v84, v116
  v_dot2_f32_bf16 v113, v85, s69, v113
  v_dot2_f32_bf16 v117, v85, v85, v117
  v_dot2_f32_bf16 v112, v86, s69, v112
  v_dot2_f32_bf16 v116, v86, v86, v116
  v_dot2_f32_bf16 v113, v87, s69, v113
  v_dot2_f32_bf16 v117, v87, v87, v117
  v_dot2_f32_bf16 v112, v88, s69, v112
  v_dot2_f32_bf16 v116, v88, v88, v116
  v_dot2_f32_bf16 v113, v89, s69, v113
  v_dot2_f32_bf16 v117, v89, v89, v117
  v_dot2_f32_bf16 v112, v90, s69, v112
  v_dot2_f32_bf16 v116, v90, v90, v116
  v_dot2_f32_bf16 v113, v91, s69, v113
  v_dot2_f32_bf16 v117, v91, v91, v117
  v_dot2_f32_bf16 v112, v92, s69, v112
  v_dot2_f32_bf16 v116, v92, v92, v116
  v_dot2_f32_bf16 v113, v93, s69, v113
  v_dot2_f32_bf16 v117, v93, v93, v117
  v_dot2_f32_bf16 v112, v94, s69, v112
  v_dot2_f32_bf16 v116, v94, v94, v116
  v_dot2_f32_bf16 v113, v95, s69, v113
  v_dot2_f32_bf16 v117, v95, v95, v117
  s_nop 2
  v_add_f32 v112, v112, v113
  v_add_f32 v116, v116, v117
  s_nop 0
  v_add_f32_dpp v112, v112, v112 quad_perm:[1,0,3,2] row_mask:0xf bank_mask:0xf
  v_add_f32_dpp v116, v116, v116 quad_perm:[1,0,3,2] row_mask:0xf bank_mask:0xf
  s_nop 0
  v_add_f32_dpp v112, v112, v112 quad_perm:[2,3,0,1] row_mask:0xf bank_mask:0xf
  v_add_f32_dpp v116, v116, v116 quad_perm:[2,3,0,1] row_mask:0xf bank_mask:0xf
  s_nop 0
  v_add_f32_dpp v112, v112, v112 row_half_mirror row_mask:0xf bank_mask:0xf
  v_add_f32_dpp v116, v116, v116 row_half_mirror row_mask:0xf bank_mask:0xf
  s_nop 0
  v_mul_f32 v120, s67, v112
  v_mul_f32 v116, s67, v116
  v_fma_f32 v116, -v120, v120, v116
  v_max_f32 v116, 0, v116
  v_cvt_pk_bf16_f32 v120, v120, v120
  v_cvt_pk_bf16_f32 v116, v116, v116
  v_and_b32 v120, 0xffff0000, v120
  v_and_b32 v116, 0xffff0000, v116
  v_add_f32 v116, s68, v116
  v_cvt_pk_bf16_f32 v116, v116, v116
  v_and_b32 v116, 0xffff0000, v116
  v_sqrt_f32 v116, v116
  s_nop 0
  v_cvt_pk_bf16_f32 v116, v116, v116
  v_and_b32 v116, 0xffff0000, v116
  v_rcp_f32 v122, v116
  s_nop 0
  v_mul_f32 v124, v120, v122
  v_sub_f32 v124, 0, v124
  v_add_u32 v6, 8, v128
  v_and_b32 v7, 15, v6
  v_xor_b32 v8, v3, v7
  v_add_u32 v9, 8, v3
  v_xor_b32 v9, v9, v7
  v_mul_u32_u24 v7, 1280, v6
  v_lshl_add_u32 v14, v8, 4, v7
  v_lshl_add_u32 v15, v9, 4, v7
  v_lshlrev_b32 v96, 16, v56
  v_and_b32 v97, 0xffff0000, v56
  v_lshlrev_b32 v98, 16, v57
  v_and_b32 v99, 0xffff0000, v57
  v_lshlrev_b32 v100, 16, v58
  v_and_b32 v101, 0xffff0000, v58
  v_lshlrev_b32 v102, 16, v59
  v_and_b32 v103, 0xffff0000, v59
  v_pk_fma_f32 v[96:97], v[96:97], v[122:123], v[124:125] op_sel_hi:[1,0,0]
  v_pk_fma_f32 v[98:99], v[98:99], v[122:123], v[124:125] op_sel_hi:[1,0,0]
  v_pk_fma_f32 v[100:101], v[100:101], v[122:123], v[124:125] op_sel_hi:[1,0,0]
  v_pk_fma_f32 v[102:103], v[102:103], v[122:123], v[124:125] op_sel_hi:[1,0,0]
  v_cvt_pk_bf16_f32 v56, v96, v97
  v_cvt_pk_bf16_f32 v57, v98, v99
  v_cvt_pk_bf16_f32 v58, v100, v101
  v_cvt_pk_bf16_f32 v59, v102, v103
  ds_write_b128 v14, v[56:59] offset:0
  v_lshlrev_b32 v104, 16, v60
  v_and_b32 v105, 0xffff0000, v60
  v_lshlrev_b32 v106, 16, v61
  v_and_b32 v107, 0xffff0000, v61
  v_lshlrev_b32 v108, 16, v62
  v_and_b32 v109, 0xffff0000, v62
  v_lshlrev_b32 v110, 16, v63
  v_and_b32 v111, 0xffff0000, v63
  v_pk_fma_f32 v[104:105], v[104:105], v[122:123], v[124:125] op_sel_hi:[1,0,0]
  v_pk_fma_f32 v[106:107], v[106:107], v[122:123], v[124:125] op_sel_hi:[1,0,0]
  v_pk_fma_f32 v[108:109], v[108:109], v[122:123], v[124:125] op_sel_hi:[1,0,0]
  v_pk_fma_f32 v[110:111], v[110:111], v[122:123], v[124:125] op_sel_hi:[1,0,0]
  v_cvt_pk_bf16_f32 v60, v104, v105
  v_cvt_pk_bf16_f32 v61, v106, v107
  v_cvt_pk_bf16_f32 v62, v108, v109
  v_cvt_pk_bf16_f32 v63, v110, v111
  ds_write_b128 v15, v[60:63] offset:0
  v_lshlrev_b32 v96, 16, v64
  v_and_b32 v97, 0xffff0000, v64
  v_lshlrev_b32 v98, 16, v65
  v_and_b32 v99, 0xffff0000, v65
  v_lshlrev_b32 v100, 16, v66
  v_and_b32 v101, 0xffff0000, v66
  v_lshlrev_b32 v102, 16, v67
  v_and_b32 v103, 0xffff0000, v67
  v_pk_fma_f32 v[96:97], v[96:97], v[122:123], v[124:125] op_sel_hi:[1,0,0]
  v_pk_fma_f32 v[98:99], v[98:99], v[122:123], v[124:125] op_sel_hi:[1,0,0]
  v_pk_fma_f32 v[100:101], v[100:101], v[122:123], v[124:125] op_sel_hi:[1,0,0]
  v_pk_fma_f32 v[102:103], v[102:103], v[122:123], v[124:125] op_sel_hi:[1,0,0]
  v_cvt_pk_bf16_f32 v64, v96, v97
  v_cvt_pk_bf16_f32 v65, v98, v99
  v_cvt_pk_bf16_f32 v66, v100, v101
  v_cvt_pk_bf16_f32 v67, v102, v103
  ds_write_b128 v14, v[64:67] offset:256
  v_lshlrev_b32 v104, 16, v68
  v_and_b32 v105, 0xffff0000, v68
  v_lshlrev_b32 v106, 16, v69
  v_and_b32 v107, 0xffff0000, v69
  v_lshlrev_b32 v108, 16, v70
  v_and_b32 v109, 0xffff0000, v70
  v_lshlrev_b32 v110, 16, v71
  v_and_b32 v111, 0xffff0000, v71
  v_pk_fma_f32 v[104:105], v[104:105], v[122:123], v[124:125] op_sel_hi:[1,0,0]
  v_pk_fma_f32 v[106:107], v[106:107], v[122:123], v[124:125] op_sel_hi:[1,0,0]
  v_pk_fma_f32 v[108:109], v[108:109], v[122:123], v[124:125] op_sel_hi:[1,0,0]
  v_pk_fma_f32 v[110:111], v[110:111], v[122:123], v[124:125] op_sel_hi:[1,0,0]
  v_cvt_pk_bf16_f32 v68, v104, v105
  v_cvt_pk_bf16_f32 v69, v106, v107
  v_cvt_pk_bf16_f32 v70, v108, v109
  v_cvt_pk_bf16_f32 v71, v110, v111
  ds_write_b128 v15, v[68:71] offset:256
  v_lshlrev_b32 v96, 16, v72
  v_and_b32 v97, 0xffff0000, v72
  v_lshlrev_b32 v98, 16, v73
  v_and_b32 v99, 0xffff0000, v73
  v_lshlrev_b32 v100, 16, v74
  v_and_b32 v101, 0xffff0000, v74
  v_lshlrev_b32 v102, 16, v75
  v_and_b32 v103, 0xffff0000, v75
  v_pk_fma_f32 v[96:97], v[96:97], v[122:123], v[124:125] op_sel_hi:[1,0,0]
  v_pk_fma_f32 v[98:99], v[98:99], v[122:123], v[124:125] op_sel_hi:[1,0,0]
  v_pk_fma_f32 v[100:101], v[100:101], v[122:123], v[124:125] op_sel_hi:[1,0,0]
  v_pk_fma_f32 v[102:103], v[102:103], v[122:123], v[124:125] op_sel_hi:[1,0,0]
  v_cvt_pk_bf16_f32 v72, v96, v97
  v_cvt_pk_bf16_f32 v73, v98, v99
  v_cvt_pk_bf16_f32 v74, v100, v101
  v_cvt_pk_bf16_f32 v75, v102, v103
  ds_write_b128 v14, v[72:75] offset:512
  v_lshlrev_b32 v104, 16, v76
  v_and_b32 v105, 0xffff0000, v76
  v_lshlrev_b32 v106, 16, v77
  v_and_b32 v107, 0xffff0000, v77
  v_lshlrev_b32 v108, 16, v78
  v_and_b32 v109, 0xffff0000, v78
  v_lshlrev_b32 v110, 16, v79
  v_and_b32 v111, 0xffff0000, v79
  v_pk_fma_f32 v[104:105], v[104:105], v[122:123], v[124:125] op_sel_hi:[1,0,0]
  v_pk_fma_f32 v[106:107], v[106:107], v[122:123], v[124:125] op_sel_hi:[1,0,0]
  v_pk_fma_f32 v[108:109], v[108:109], v[122:123], v[124:125] op_sel_hi:[1,0,0]
  v_pk_fma_f32 v[110:111], v[110:111], v[122:123], v[124:125] op_sel_hi:[1,0,0]
  v_cvt_pk_bf16_f32 v76, v104, v105
  v_cvt_pk_bf16_f32 v77, v106, v107
  v_cvt_pk_bf16_f32 v78, v108, v109
  v_cvt_pk_bf16_f32 v79, v110, v111
  ds_write_b128 v15, v[76:79] offset:512
  v_lshlrev_b32 v96, 16, v80
  v_and_b32 v97, 0xffff0000, v80
  v_lshlrev_b32 v98, 16, v81
  v_and_b32 v99, 0xffff0000, v81
  v_lshlrev_b32 v100, 16, v82
  v_and_b32 v101, 0xffff0000, v82
  v_lshlrev_b32 v102, 16, v83
  v_and_b32 v103, 0xffff0000, v83
  v_pk_fma_f32 v[96:97], v[96:97], v[122:123], v[124:125] op_sel_hi:[1,0,0]
  v_pk_fma_f32 v[98:99], v[98:99], v[122:123], v[124:125] op_sel_hi:[1,0,0]
  v_pk_fma_f32 v[100:101], v[100:101], v[122:123], v[124:125] op_sel_hi:[1,0,0]
  v_pk_fma_f32 v[102:103], v[102:103], v[122:123], v[124:125] op_sel_hi:[1,0,0]
  v_cvt_pk_bf16_f32 v80, v96, v97
  v_cvt_pk_bf16_f32 v81, v98, v99
  v_cvt_pk_bf16_f32 v82, v100, v101
  v_cvt_pk_bf16_f32 v83, v102, v103
  ds_write_b128 v14, v[80:83] offset:768
  v_lshlrev_b32 v104, 16, v84
  v_and_b32 v105, 0xffff0000, v84
  v_lshlrev_b32 v106, 16, v85
  v_and_b32 v107, 0xffff0000, v85
  v_lshlrev_b32 v108, 16, v86
  v_and_b32 v109, 0xffff0000, v86
  v_lshlrev_b32 v110, 16, v87
  v_and_b32 v111, 0xffff0000, v87
  v_pk_fma_f32 v[104:105], v[104:105], v[122:123], v[124:125] op_sel_hi:[1,0,0]
  v_pk_fma_f32 v[106:107], v[106:107], v[122:123], v[124:125] op_sel_hi:[1,0,0]
  v_pk_fma_f32 v[108:109], v[108:109], v[122:123], v[124:125] op_sel_hi:[1,0,0]
  v_pk_fma_f32 v[110:111], v[110:111], v[122:123], v[124:125] op_sel_hi:[1,0,0]
  v_cvt_pk_bf16_f32 v84, v104, v105
  v_cvt_pk_bf16_f32 v85, v106, v107
  v_cvt_pk_bf16_f32 v86, v108, v109
  v_cvt_pk_bf16_f32 v87, v110, v111
  ds_write_b128 v15, v[84:87] offset:768
  v_lshlrev_b32 v96, 16, v88
  v_and_b32 v97, 0xffff0000, v88
  v_lshlrev_b32 v98, 16, v89
  v_and_b32 v99, 0xffff0000, v89
  v_lshlrev_b32 v100, 16, v90
  v_and_b32 v101, 0xffff0000, v90
  v_lshlrev_b32 v102, 16, v91
  v_and_b32 v103, 0xffff0000, v91
  v_pk_fma_f32 v[96:97], v[96:97], v[122:123], v[124:125] op_sel_hi:[1,0,0]
  v_pk_fma_f32 v[98:99], v[98:99], v[122:123], v[124:125] op_sel_hi:[1,0,0]
  v_pk_fma_f32 v[100:101], v[100:101], v[122:123], v[124:125] op_sel_hi:[1,0,0]
  v_pk_fma_f32 v[102:103], v[102:103], v[122:123], v[124:125] op_sel_hi:[1,0,0]
  v_cvt_pk_bf16_f32 v88, v96, v97
  v_cvt_pk_bf16_f32 v89, v98, v99
  v_cvt_pk_bf16_f32 v90, v100, v101
  v_cvt_pk_bf16_f32 v91, v102, v103
  ds_write_b128 v14, v[88:91] offset:1024
  v_lshlrev_b32 v104, 16, v92
  v_and_b32 v105, 0xffff0000, v92
  v_lshlrev_b32 v106, 16, v93
  v_and_b32 v107, 0xffff0000, v93
  v_lshlrev_b32 v108, 16, v94
  v_and_b32 v109, 0xffff0000, v94
  v_lshlrev_b32 v110, 16, v95
  v_and_b32 v111, 0xffff0000, v95
  v_pk_fma_f32 v[104:105], v[104:105], v[122:123], v[124:125] op_sel_hi:[1,0,0]
  v_pk_fma_f32 v[106:107], v[106:107], v[122:123], v[124:125] op_sel_hi:[1,0,0]
  v_pk_fma_f32 v[108:109], v[108:109], v[122:123], v[124:125] op_sel_hi:[1,0,0]
  v_pk_fma_f32 v[110:111], v[110:111], v[122:123], v[124:125] op_sel_hi:[1,0,0]
  v_cvt_pk_bf16_f32 v92, v104, v105
  v_cvt_pk_bf16_f32 v93, v106, v107
  v_cvt_pk_bf16_f32 v94, v108, v109
  v_cvt_pk_bf16_f32 v95, v110, v111
  ds_write_b128 v15, v[92:95] offset:1024
  s_waitcnt lgkmcnt(0)
  s_barrier
  ds_read_b128 v[16:19], v160 offset:0
  ds_read_b128 v[20:23], v160 offset:20480
  ds_read_b128 v[24:27], v170 offset:0
  ds_read_b128 v[28:31], v170 offset:20480
  ds_read_b64_tr_b16 v[32:33], v164 offset:0
  ds_read_b64_tr_b16 v[34:35], v164 offset:2560
  ds_read_b64_tr_b16 v[36:37], v165 offset:0
  ds_read_b64_tr_b16 v[38:39], v165 offset:2560
  ds_read_b64_tr_b16 v[40:41], v166 offset:0
  ds_read_b64_tr_b16 v[42:43], v166 offset:2560
  ds_read_b64_tr_b16 v[44:45], v167 offset:0
  ds_read_b64_tr_b16 v[46:47], v167 offset:2560
  ds_read_b64_tr_b16 v[48:49], v168 offset:0
  ds_read_b64_tr_b16 v[50:51], v168 offset:2560
  ds_read_b64_tr_b16 v[52:53], v169 offset:0
  ds_read_b64_tr_b16 v[54:55], v169 offset:2560
  s_mov_b32 s62, 5
  s_waitcnt lgkmcnt(0)
L_W_cloop:
  s_barrier
  v_mfma_f32_16x16x32_bf16 v[176:179], v[32:35], v[16:19], v[176:179]
  ds_read_b128 v[56:59], v161 offset:0
  v_mfma_f32_16x16x32_bf16 v[180:183], v[32:35], v[20:23], v[180:183]
  ds_read_b128 v[60:63], v161 offset:20480
  v_mfma_f32_16x16x32_bf16 v[184:187], v[32:35], v[24:27], v[184:187]
  ds_read_b128 v[64:67], v171 offset:0
  v_mfma_f32_16x16x32_bf16 v[188:191], v[32:35], v[28:31], v[188:191]
  ds_read_b128 v[68:71], v171 offset:20480
  v_mfma_f32_16x16x32_bf16 v[192:195], v[36:39], v[16:19], v[192:195]
  ds_read_b64_tr_b16 v[72:73], v164 offset:20480
  v_mfma_f32_16x16x32_bf16 v[196:199], v[36:39], v[20:23], v[196:199]
  ds_read_b64_tr_b16 v[74:75], v164 offset:23040
  v_mfma_f32_16x16x32_bf16 v[200:203], v[36:39], v[24:27], v[200:203]
  ds_read_b64_tr_b16 v[76:77], v165 offset:20480
  v_mfma_f32_16x16x32_bf16 v[204:207], v[36:39], v[28:31], v[204:207]
  ds_read_b64_tr_b16 v[78:79], v165 offset:23040
  v_mfma_f32_16x16x32_bf16 v[208:211], v[40:43], v[16:19], v[208:211]
  ds_read_b64_tr_b16 v[80:81], v166 offset:20480
  v_mfma_f32_16x16x32_bf16 v[212:215], v[40:43], v[20:23], v[212:215]
  ds_read_b64_tr_b16 v[82:83], v166 offset:23040
  v_mfma_f32_16x16x32_bf16 v[216:219], v[40:43], v[24:27], v[216:219]
  ds_read_b64_tr_b16 v[84:85], v167 offset:20480
  v_mfma_f32_16x16x32_bf16 v[220:223], v[40:43], v[28:31], v[220:223]
  ds_read_b64_tr_b16 v[86:87], v167 offset:23040
  v_mfma_f32_16x16x32_bf16 v[224:227], v[44:47], v[16:19], v[224:227]
  ds_read_b64_tr_b16 v[88:89], v168 offset:20480
  v_mfma_f32_16x16x32_bf16 v[228:231], v[44:47], v[20:23], v[228:231]
  ds_read_b64_tr_b16 v[90:91], v168 offset:23040
  v_mfma_f32_16x16x32_bf16 v[232:235], v[44:47], v[24:27], v[232:235]
  ds_read_b64_tr_b16 v[92:93], v169 offset:20480
  v_mfma_f32_16x16x32_bf16 v[236:239], v[44:47], v[28:31], v[236:239]
  ds_read_b64_tr_b16 v[94:95], v169 offset:23040
  v_mfma_f32_16x16x32_bf16 v[240:243], v[48:51], v[16:19], v[240:243]
  v_mfma_f32_16x16x32_bf16 v[244:247], v[48:51], v[20:23], v[244:247]
  v_mfma_f32_16x16x32_bf16 v[248:251], v[52:55], v[16:19], v[248:251]
  v_mfma_f32_16x16x32_bf16 v[252:255], v[52:55], v[20:23], v[252:255]
  s_waitcnt lgkmcnt(0)
  s_barrier
  v_mfma_f32_16x16x32_bf16 v[176:179], v[72:75], v[56:59], v[176:179]
  ds_read_b128 v[16:19], v162 offset:0
  v_mfma_f32_16x16x32_bf16 v[180:183], v[72:75], v[60:63], v[180:183]
  ds_read_b128 v[20:23], v162 offset:20480
  v_mfma_f32_16x16x32_bf16 v[184:187], v[72:75], v[64:67], v[184:187]
  ds_read_b128 v[24:27], v172 offset:0
  v_mfma_f32_16x16x32_bf16 v[188:191], v[72:75], v[68:71], v[188:191]
  ds_read_b128 v[28:31], v172 offset:20480
  v_mfma_f32_16x16x32_bf16 v[192:195], v[76:79], v[56:59], v[192:195]
  ds_read_b64_tr_b16 v[32:33], v164 offset:40960
  v_mfma_f32_16x16x32_bf16 v[196:199], v[76:79], v[60:63], v[196:199]
  ds_read_b64_tr_b16 v[34:35], v164 offset:43520
  v_mfma_f32_16x16x32_bf16 v[200:203], v[76:79], v[64:67], v[200:203]
  ds_read_b64_tr_b16 v[36:37], v165 offset:40960
  v_mfma_f32_16x16x32_bf16 v[204:207], v[76:79], v[68:71], v[204:207]
  ds_read_b64_tr_b16 v[38:39], v165 offset:43520
  v_mfma_f32_16x16x32_bf16 v[208:211], v[80:83], v[56:59], v[208:211]
  ds_read_b64_tr_b16 v[40:41], v166 offset:40960
  v_mfma_f32_16x16x32_bf16 v[212:215], v[80:83], v[60:63], v[212:215]
  ds_read_b64_tr_b16 v[42:43], v166 offset:43520
  v_mfma_f32_16x16x32_bf16 v[216:219], v[80:83], v[64:67], v[216:219]
  ds_read_b64_tr_b16 v[44:45], v167 offset:40960
  v_mfma_f32_16x16x32_bf16 v[220:223], v[80:83], v[68:71], v[220:223]
  ds_read_b64_tr_b16 v[46:47], v167 offset:43520
  v_mfma_f32_16x16x32_bf16 v[224:227], v[84:87], v[56:59], v[224:227]
  ds_read_b64_tr_b16 v[48:49], v168 offset:40960
  v_mfma_f32_16x16x32_bf16 v[228:231], v[84:87], v[60:63], v[228:231]
  ds_read_b64_tr_b16 v[50:51], v168 offset:43520
  v_mfma_f32_16x16x32_bf16 v[232:235], v[84:87], v[64:67], v[232:235]
  ds_read_b64_tr_b16 v[52:53], v169 offset:40960
  v_mfma_f32_16x16x32_bf16 v[236:239], v[84:87], v[68:71], v[236:239]
  ds_read_b64_tr_b16 v[54:55], v169 offset:43520
  v_mfma_f32_16x16x32_bf16 v[240:243], v[88:91], v[56:59], v[240:243]
  v_mfma_f32_16x16x32_bf16 v[244:247], v[88:91], v[60:63], v[244:247]
  v_mfma_f32_16x16x32_bf16 v[248:251], v[92:95], v[56:59], v[248:251]
  v_mfma_f32_16x16x32_bf16 v[252:255], v[92:95], v[60:63], v[252:255]
  s_waitcnt lgkmcnt(0)
  s_barrier
  v_mfma_f32_16x16x32_bf16 v[176:179], v[32:35], v[16:19], v[176:179]
  ds_read_b128 v[56:59], v163 offset:0
  v_mfma_f32_16x16x32_bf16 v[180:183], v[32:35], v[20:23], v[180:183]
  ds_read_b128 v[60:63], v163 offset:20480
  v_mfma_f32_16x16x32_bf16 v[184:187], v[32:35], v[24:27], v[184:187]
  ds_read_b128 v[64:67], v173 offset:0
  v_mfma_f32_16x16x32_bf16 v[188:191], v[32:35], v[28:31], v[188:191]
  ds_read_b128 v[68:71], v173 offset:20480
  v_mfma_f32_16x16x32_bf16 v[192:195], v[36:39], v[16:19], v[192:195]
  ds_read_b64_tr_b16 v[72:73], v164 offset:61440
  v_mfma_f32_16x16x32_bf16 v[196:199], v[36:39], v[20:23], v[196:199]
  ds_read_b64_tr_b16 v[74:75], v164 offset:64000
  v_mfma_f32_16x16x32_bf16 v[200:203], v[36:39], v[24:27], v[200:203]
  ds_read_b64_tr_b16 v[76:77], v165 offset:61440
  v_mfma_f32_16x16x32_bf16 v[204:207], v[36:39], v[28:31], v[204:207]
  ds_read_b64_tr_b16 v[78:79], v165 offset:64000
  v_mfma_f32_16x16x32_bf16 v[208:211], v[40:43], v[16:19], v[208:211]
  ds_read_b64_tr_b16 v[80:81], v166 offset:61440
  v_mfma_f32_16x16x32_bf16 v[212:215], v[40:43], v[20:23], v[212:215]
  ds_read_b64_tr_b16 v[82:83], v166 offset:64000
  v_mfma_f32_16x16x32_bf16 v[216:219], v[40:43], v[24:27], v[216:219]
  ds_read_b64_tr_b16 v[84:85], v167 offset:61440
  v_mfma_f32_16x16x32_bf16 v[220:223], v[40:43], v[28:31], v[220:223]
  ds_read_b64_tr_b16 v[86:87], v167 offset:64000
  v_mfma_f32_16x16x32_bf16 v[224:227], v[44:47], v[16:19], v[224:227]
  ds_read_b64_tr_b16 v[88:89], v168 offset:61440
  v_mfma_f32_16x16x32_bf16 v[228:231], v[44:47], v[20:23], v[228:231]
  ds_read_b64_tr_b16 v[90:91], v168 offset:64000
  v_mfma_f32_16x16x32_bf16 v[232:235], v[44:47], v[24:27], v[232:235]
  ds_read_b64_tr_b16 v[92:93], v169 offset:61440
  v_mfma_f32_16x16x32_bf16 v[236:239], v[44:47], v[28:31], v[236:239]
  ds_read_b64_tr_b16 v[94:95], v169 offset:64000
  v_mfma_f32_16x16x32_bf16 v[240:243], v[48:51], v[16:19], v[240:243]
  v_mfma_f32_16x16x32_bf16 v[244:247], v[48:51], v[20:23], v[244:247]
  v_mfma_f32_16x16x32_bf16 v[248:251], v[52:55], v[16:19], v[248:251]
  v_mfma_f32_16x16x32_bf16 v[252:255], v[52:55], v[20:23], v[252:255]
  s_waitcnt lgkmcnt(0)
  s_barrier
  v_mfma_f32_16x16x32_bf16 v[176:179], v[72:75], v[56:59], v[176:179]
  ds_read_b128 v[16:19], v160 offset:256
  v_mfma_f32_16x16x32_bf16 v[180:183], v[72:75], v[60:63], v[180:183]
  ds_read_b128 v[20:23], v160 offset:20736
  v_mfma_f32_16x16x32_bf16 v[184:187], v[72:75], v[64:67], v[184:187]
  ds_read_b128 v[24:27], v170 offset:256
  v_mfma_f32_16x16x32_bf16 v[188:191], v[72:75], v[68:71], v[188:191]
  ds_read_b128 v[28:31], v170 offset:20736
  v_mfma_f32_16x16x32_bf16 v[192:195], v[76:79], v[56:59], v[192:195]
  ds_read_b64_tr_b16 v[32:33], v164 offset:0
  v_mfma_f32_16x16x32_bf16 v[196:199], v[76:79], v[60:63], v[196:199]
  ds_read_b64_tr_b16 v[34:35], v164 offset:2560
  v_mfma_f32_16x16x32_bf16 v[200:203], v[76:79], v[64:67], v[200:203]
  ds_read_b64_tr_b16 v[36:37], v165 offset:0
  v_mfma_f32_16x16x32_bf16 v[204:207], v[76:79], v[68:71], v[204:207]
  ds_read_b64_tr_b16 v[38:39], v165 offset:2560
  v_mfma_f32_16x16x32_bf16 v[208:211], v[80:83], v[56:59], v[208:211]
  ds_read_b64_tr_b16 v[40:41], v166 offset:0
  v_mfma_f32_16x16x32_bf16 v[212:215], v[80:83], v[60:63], v[212:215]
  ds_read_b64_tr_b16 v[42:43], v166 offset:2560
  v_mfma_f32_16x16x32_bf16 v[216:219], v[80:83], v[64:67], v[216:219]
  ds_read_b64_tr_b16 v[44:45], v167 offset:0
  v_mfma_f32_16x16x32_bf16 v[220:223], v[80:83], v[68:71], v[220:223]
  ds_read_b64_tr_b16 v[46:47], v167 offset:2560
  v_mfma_f32_16x16x32_bf16 v[224:227], v[84:87], v[56:59], v[224:227]
  ds_read_b64_tr_b16 v[48:49], v168 offset:0
  v_mfma_f32_16x16x32_bf16 v[228:231], v[84:87], v[60:63], v[228:231]
  ds_read_b64_tr_b16 v[50:51], v168 offset:2560
  v_mfma_f32_16x16x32_bf16 v[232:235], v[84:87], v[64:67], v[232:235]
  ds_read_b64_tr_b16 v[52:53], v169 offset:0
  v_mfma_f32_16x16x32_bf16 v[236:239], v[84:87], v[68:71], v[236:239]
  ds_read_b64_tr_b16 v[54:55], v169 offset:2560
  v_mfma_f32_16x16x32_bf16 v[240:243], v[88:91], v[56:59], v[240:243]
  v_mfma_f32_16x16x32_bf16 v[244:247], v[88:91], v[60:63], v[244:247]
  v_mfma_f32_16x16x32_bf16 v[248:251], v[92:95], v[56:59], v[248:251]
  v_mfma_f32_16x16x32_bf16 v[252:255], v[92:95], v[60:63], v[252:255]
  v_add_u32 v160, 0x100, v160
  v_add_u32 v170, 0x100, v170
  v_add_u32 v161, 0x100, v161
  v_add_u32 v171, 0x100, v171
  v_add_u32 v162, 0x100, v162
  v_add_u32 v172, 0x100, v172
  v_add_u32 v163, 0x100, v163
  v_add_u32 v173, 0x100, v173
  s_waitcnt lgkmcnt(0)
  s_sub_u32 s62, s62, 1
  s_cmp_lg_u32 s62, 0
  s_cbranch_scc1 L_W_cloop
  s_mov_b32 s92, s10
  s_mov_b32 s93, s11
  s_mov_b32 s94, 256
  s_mov_b32 s95, 0x00020000
  s_add_u32 s96, s20, 20971520
  s_addc_u32 s97, s21, 0
  s_mov_b32 s98, 262144
  s_mov_b32 s99, 0x00020000
  v_mov_b32 v6, 0
  buffer_load_dword v130, v6, s[92:95], 0 offen sc1
  v_lshlrev_b32 v6, 4, v1
  v_add_u32 v7, 8, v6
  s_mul_i32 s56, s53, 54
  s_lshl_b32 s57, s54, 1
  s_add_u32 s56, s56, s57
  s_nop 4
  s_and_b32 s57, s52, 1
  s_lshl_b32 s57, s57, 11
  s_sub_u32 s58, 2048, s57
  v_add_u32 v7, s58, v6
  v_add_u32 v6, s57, v6
  s_lshl_b32 s57, s52, 1
  s_add_u32 s57, s57, s56
  s_add_u32 s58, s57, 0
  s_lshl_b32 s58, s58, 12
  v_cvt_pk_bf16_f32 v16, v176, v177
  v_cvt_pk_bf16_f32 v17, v178, v179
  v_pk_max_i16 v16, v16, 0
  v_pk_max_i16 v17, v17, 0
  v_cvt_pk_bf16_f32 v18, v192, v193
  v_cvt_pk_bf16_f32 v19, v194, v195
  v_pk_max_i16 v18, v18, 0
  v_pk_max_i16 v19, v19, 0
  buffer_store_dwordx4 v[16:19], v6, s[32:35], s58 offen offset:0 sc1
  v_cvt_pk_bf16_f32 v20, v180, v181
  v_cvt_pk_bf16_f32 v21, v182, v183
  v_pk_max_i16 v20, v20, 0
  v_pk_max_i16 v21, v21, 0
  v_cvt_pk_bf16_f32 v22, v196, v197
  v_cvt_pk_bf16_f32 v23, v198, v199
  v_pk_max_i16 v22, v22, 0
  v_pk_max_i16 v23, v23, 0
  buffer_store_dwordx4 v[20:23], v6, s[32:35], s58 offen offset:1024 sc1
  v_cvt_pk_bf16_f32 v24, v184, v185
  v_cvt_pk_bf16_f32 v25, v186, v187
  v_pk_max_i16 v24, v24, 0
  v_pk_max_i16 v25, v25, 0
  v_cvt_pk_bf16_f32 v26, v200, v201
  v_cvt_pk_bf16_f32 v27, v202, v203
  v_pk_max_i16 v26, v26, 0
  v_pk_max_i16 v27, v27, 0
  buffer_store_dwordx4 v[24:27], v7, s[32:35], s58 offen offset:0 sc1
  v_cvt_pk_bf16_f32 v28, v188, v189
  v_cvt_pk_bf16_f32 v29, v190, v191
  v_pk_max_i16 v28, v28, 0
  v_pk_max_i16 v29, v29, 0
  v_cvt_pk_bf16_f32 v30, v204, v205
  v_cvt_pk_bf16_f32 v31, v206, v207
  v_pk_max_i16 v30, v30, 0
  v_pk_max_i16 v31, v31, 0
  buffer_store_dwordx4 v[28:31], v7, s[32:35], s58 offen offset:1024 sc1
  s_add_u32 s58, s57, 1
  s_lshl_b32 s58, s58, 12
  v_cvt_pk_bf16_f32 v32, v208, v209
  v_cvt_pk_bf16_f32 v33, v210, v211
  v_pk_max_i16 v32, v32, 0
  v_pk_max_i16 v33, v33, 0
  v_cvt_pk_bf16_f32 v34, v224, v225
  v_cvt_pk_bf16_f32 v35, v226, v227
  v_pk_max_i16 v34, v34, 0
  v_pk_max_i16 v35, v35, 0
  buffer_store_dwordx4 v[32:35], v6, s[32:35], s58 offen offset:0 sc1
  v_cvt_pk_bf16_f32 v36, v212, v213
  v_cvt_pk_bf16_f32 v37, v214, v215
  v_pk_max_i16 v36, v36, 0
  v_pk_max_i16 v37, v37, 0
  v_cvt_pk_bf16_f32 v38, v228, v229
  v_cvt_pk_bf16_f32 v39, v230, v231
  v_pk_max_i16 v38, v38, 0
  v_pk_max_i16 v39, v39, 0
  buffer_store_dwordx4 v[36:39], v6, s[32:35], s58 offen offset:1024 sc1
  v_cvt_pk_bf16_f32 v40, v216, v217
  v_cvt_pk_bf16_f32 v41, v218, v219
  v_pk_max_i16 v40, v40, 0
  v_pk_max_i16 v41, v41, 0
  v_cvt_pk_bf16_f32 v42, v232, v233
  v_cvt_pk_bf16_f32 v43, v234, v235
  v_pk_max_i16 v42, v42, 0
  v_pk_max_i16 v43, v43, 0
  buffer_store_dwordx4 v[40:43], v7, s[32:35], s58 offen offset:0 sc1
  v_cvt_pk_bf16_f32 v44, v220, v221
  v_cvt_pk_bf16_f32 v45, v222, v223
  v_pk_max_i16 v44, v44, 0
  v_pk_max_i16 v45, v45, 0
  v_cvt_pk_bf16_f32 v46, v236, v237
  v_cvt_pk_bf16_f32 v47, v238, v239
  v_pk_max_i16 v46, v46, 0
  v_pk_max_i16 v47, v47, 0
  buffer_store_dwordx4 v[44:47], v7, s[32:35], s58 offen offset:1024 sc1
  s_lshr_b32 s58, s52, 1
  s_add_u32 s58, s58, s56
  s_add_u32 s58, s58, 8
  s_lshl_b32 s58, s58, 12
  v_cvt_pk_bf16_f32 v48, v240, v241
  v_cvt_pk_bf16_f32 v49, v242, v243
  v_pk_max_i16 v48, v48, 0
  v_pk_max_i16 v49, v49, 0
  v_cvt_pk_bf16_f32 v50, v248, v249
  v_cvt_pk_bf16_f32 v51, v250, v251
  v_pk_max_i16 v50, v50, 0
  v_pk_max_i16 v51, v51, 0
  buffer_store_dwordx4 v[48:51], v6, s[32:35], s58 offen offset:0 sc1
  v_cvt_pk_bf16_f32 v52, v244, v245
  v_cvt_pk_bf16_f32 v53, v246, v247
  v_pk_max_i16 v52, v52, 0
  v_pk_max_i16 v53, v53, 0
  v_cvt_pk_bf16_f32 v54, v252, v253
  v_cvt_pk_bf16_f32 v55, v254, v255
  v_pk_max_i16 v54, v54, 0
  v_pk_max_i16 v55, v55, 0
  buffer_store_dwordx4 v[52:55], v6, s[32:35], s58 offen offset:1024 sc1
  s_branch L_h_done
L_N_cons:
  s_add_u32 s32, s20, 0
  s_addc_u32 s33, s21, 0
  s_mov_b32 s34, 7077888
  s_mov_b32 s35, 0x00020000
  v_add_u32 v7, 0, v5
  v_xor_b32 v7, v7, v4
  v_lshlrev_b32 v7, 4, v7
  v_mul_u32_u24 v8, 1280, v4
  v_add_u32 v160, v7, v8
  v_add_u32 v7, 4, v5
  v_xor_b32 v7, v7, v4
  v_lshlrev_b32 v7, 4, v7
  v_mul_u32_u24 v8, 1280, v4
  v_add_u32 v161, v7, v8
  v_add_u32 v7, 8, v5
  v_xor_b32 v7, v7, v4
  v_lshlrev_b32 v7, 4, v7
  v_mul_u32_u24 v8, 1280, v4
  v_add_u32 v162, v7, v8
  v_add_u32 v7, 12, v5
  v_xor_b32 v7, v7, v4
  v_lshlrev_b32 v7, 4, v7
  v_mul_u32_u24 v8, 1280, v4
  v_add_u32 v163, v7, v8
  v_bfe_u32 v7, v1, 2, 2
  v_and_b32 v8, 3, v1
  v_lshl_add_u32 v9, v5, 3, v7
  v_mul_u32_u24 v9, 512, v9
  v_lshl_add_u32 v9, v8, 3, v9
  v_add_u32 v9, 81920, v9
  v_and_b32 v10, 1, v5
  v_lshl_or_b32 v10, v10, 2, v7
  s_lshl_b32 s57, s52, 2
  s_add_u32 s57, s57, 0
  v_xor_b32 v11, s57, v10
  v_lshl_add_u32 v164, v11, 5, v9
  s_lshl_b32 s57, s52, 2
  s_add_u32 s57, s57, 1
  v_xor_b32 v11, s57, v10
  v_lshl_add_u32 v165, v11, 5, v9
  s_lshl_b32 s57, s52, 2
  s_add_u32 s57, s57, 2
  v_xor_b32 v11, s57, v10
  v_lshl_add_u32 v166, v11, 5, v9
  s_lshl_b32 s57, s52, 2
  s_add_u32 s57, s57, 3
  v_xor_b32 v11, s57, v10
  v_lshl_add_u32 v167, v11, 5, v9
  v_mov_b32 v176, 0
  v_mov_b32 v177, 0
  v_mov_b32 v178, 0
  v_mov_b32 v179, 0
  v_mov_b32 v180, 0
  v_mov_b32 v181, 0
  v_mov_b32 v182, 0
  v_mov_b32 v183, 0
  v_mov_b32 v184, 0
  v_mov_b32 v185, 0
  v_mov_b32 v186, 0
  v_mov_b32 v187, 0
  v_mov_b32 v188, 0
  v_mov_b32 v189, 0
  v_mov_b32 v190, 0
  v_mov_b32 v191, 0
  v_mov_b32 v192, 0
  v_mov_b32 v193, 0
  v_mov_b32 v194, 0
  v_mov_b32 v195, 0
  v_mov_b32 v196, 0
  v_mov_b32 v197, 0
  v_mov_b32 v198, 0
  v_mov_b32 v199, 0
  v_mov_b32 v200, 0
  v_mov_b32 v201, 0
  v_mov_b32 v202, 0
  v_mov_b32 v203, 0
  v_mov_b32 v204, 0
  v_mov_b32 v205, 0
  v_mov_b32 v206, 0
  v_mov_b32 v207, 0
  v_mov_b32 v208, 0
  v_mov_b32 v209, 0
  v_mov_b32 v210, 0
  v_mov_b32 v211, 0
  v_mov_b32 v212, 0
  v_mov_b32 v213, 0
  v_mov_b32 v214, 0
  v_mov_b32 v215, 0
  v_mov_b32 v216, 0
  v_mov_b32 v217, 0
  v_mov_b32 v218, 0
  v_mov_b32 v219, 0
  v_mov_b32 v220, 0
  v_mov_b32 v221, 0
  v_mov_b32 v222, 0
  v_mov_b32 v223, 0
  v_mov_b32 v224, 0
  v_mov_b32 v225, 0
  v_mov_b32 v226, 0
  v_mov_b32 v227, 0
  v_mov_b32 v228, 0
  v_mov_b32 v229, 0
  v_mov_b32 v230, 0
  v_mov_b32 v231, 0
  v_mov_b32 v232, 0
  v_mov_b32 v233, 0
  v_mov_b32 v234, 0
  v_mov_b32 v235, 0
  v_mov_b32 v236, 0
  v_mov_b32 v237, 0
  v_mov_b32 v238, 0
  v_mov_b32 v239, 0
  s_waitcnt vmcnt(10)
  v_dot2_f32_bf16 v112, v16, s69, 0
  v_dot2_f32_bf16 v116, v16, v16, 0
  v_dot2_f32_bf16 v113, v17, s69, 0
  v_dot2_f32_bf16 v117, v17, v17, 0
  v_dot2_f32_bf16 v112, v18, s69, v112
  v_dot2_f32_bf16 v116, v18, v18, v116
  v_dot2_f32_bf16 v113, v19, s69, v113
  v_dot2_f32_bf16 v117, v19, v19, v117
  v_dot2_f32_bf16 v112, v20, s69, v112
  v_dot2_f32_bf16 v116, v20, v20, v116
  v_dot2_f32_bf16 v113, v21, s69, v113
  v_dot2_f32_bf16 v117, v21, v21, v117
  v_dot2_f32_bf16 v112, v22, s69, v112
  v_dot2_f32_bf16 v116, v22, v22, v116
  v_dot2_f32_bf16 v113, v23, s69, v113
  v_dot2_f32_bf16 v117, v23, v23, v117
  v_dot2_f32_bf16 v112, v24, s69, v112
  v_dot2_f32_bf16 v116, v24, v24, v116
  v_dot2_f32_bf16 v113, v25, s69, v113
  v_dot2_f32_bf16 v117, v25, v25, v117
  v_dot2_f32_bf16 v112, v26, s69, v112
  v_dot2_f32_bf16 v116, v26, v26, v116
  v_dot2_f32_bf16 v113, v27, s69, v113
  v_dot2_f32_bf16 v117, v27, v27, v117
  v_dot2_f32_bf16 v112, v28, s69, v112
  v_dot2_f32_bf16 v116, v28, v28, v116
  v_dot2_f32_bf16 v113, v29, s69, v113
  v_dot2_f32_bf16 v117, v29, v29, v117
  v_dot2_f32_bf16 v112, v30, s69, v112
  v_dot2_f32_bf16 v116, v30, v30, v116
  v_dot2_f32_bf16 v113, v31, s69, v113
  v_dot2_f32_bf16 v117, v31, v31, v117
  v_dot2_f32_bf16 v112, v32, s69, v112
  v_dot2_f32_bf16 v116, v32, v32, v116
  v_dot2_f32_bf16 v113, v33, s69, v113
  v_dot2_f32_bf16 v117, v33, v33, v117
  v_dot2_f32_bf16 v112, v34, s69, v112
  v_dot2_f32_bf16 v116, v34, v34, v116
  v_dot2_f32_bf16 v113, v35, s69, v113
  v_dot2_f32_bf16 v117, v35, v35, v117
  v_dot2_f32_bf16 v112, v36, s69, v112
  v_dot2_f32_bf16 v116, v36, v36, v116
  v_dot2_f32_bf16 v113, v37, s69, v113
  v_dot2_f32_bf16 v117, v37, v37, v117
  v_dot2_f32_bf16 v112, v38, s69, v112
  v_dot2_f32_bf16 v116, v38, v38, v116
  v_dot2_f32_bf16 v113, v39, s69, v113
  v_dot2_f32_bf16 v117, v39, v39, v117
  v_dot2_f32_bf16 v112, v40, s69, v112
  v_dot2_f32_bf16 v116, v40, v40, v116
  v_dot2_f32_bf16 v113, v41, s69, v113
  v_dot2_f32_bf16 v117, v41, v41, v117
  v_dot2_f32_bf16 v112, v42, s69, v112
  v_dot2_f32_bf16 v116, v42, v42, v116
  v_dot2_f32_bf16 v113, v43, s69, v113
  v_dot2_f32_bf16 v117, v43, v43, v117
  v_dot2_f32_bf16 v112, v44, s69, v112
  v_dot2_f32_bf16 v116, v44, v44, v116
  v_dot2_f32_bf16 v113, v45, s69, v113
  v_dot2_f32_bf16 v117, v45, v45, v117
  v_dot2_f32_bf16 v112, v46, s69, v112
  v_dot2_f32_bf16 v116, v46, v46, v116
  v_dot2_f32_bf16 v113, v47, s69, v113
  v_dot2_f32_bf16 v117, v47, v47, v117
  v_dot2_f32_bf16 v112, v48, s69, v112
  v_dot2_f32_bf16 v116, v48, v48, v116
  v_dot2_f32_bf16 v113, v49, s69, v113
  v_dot2_f32_bf16 v117, v49, v49, v117
  v_dot2_f32_bf16 v112, v50, s69, v112
  v_dot2_f32_bf16 v116, v50, v50, v116
  v_dot2_f32_bf16 v113, v51, s69, v113
  v_dot2_f32_bf16 v117, v51, v51, v117
  v_dot2_f32_bf16 v112, v52, s69, v112
  v_dot2_f32_bf16 v116, v52, v52, v116
  v_dot2_f32_bf16 v113, v53, s69, v113
  v_dot2_f32_bf16 v117, v53, v53, v117
  v_dot2_f32_bf16 v112, v54, s69, v112
  v_dot2_f32_bf16 v116, v54, v54, v116
  v_dot2_f32_bf16 v113, v55, s69, v113
  v_dot2_f32_bf16 v117, v55, v55, v117
  s_nop 2
  v_add_f32 v112, v112, v113
  v_add_f32 v116, v116, v117
  s_nop 0
  v_add_f32_dpp v112, v112, v112 quad_perm:[1,0,3,2] row_mask:0xf bank_mask:0xf
  v_add_f32_dpp v116, v116, v116 quad_perm:[1,0,3,2] row_mask:0xf bank_mask:0xf
  s_nop 0
  v_add_f32_dpp v112, v112, v112 quad_perm:[2,3,0,1] row_mask:0xf bank_mask:0xf
  v_add_f32_dpp v116, v116, v116 quad_perm:[2,3,0,1] row_mask:0xf bank_mask:0xf
  s_nop 0
  v_add_f32_dpp v112, v112, v112 row_half_mirror row_mask:0xf bank_mask:0xf
  v_add_f32_dpp v116, v116, v116 row_half_mirror row_mask:0xf bank_mask:0xf
  s_nop 0
  v_mul_f32 v120, s67, v112
  v_mul_f32 v116, s67, v116
  v_fma_f32 v116, -v120, v120, v116
  v_max_f32 v116, 0, v116
  v_cvt_pk_bf16_f32 v120, v120, v120
  v_cvt_pk_bf16_f32 v116, v116, v116
  v_and_b32 v120, 0xffff0000, v120
  v_and_b32 v116, 0xffff0000, v116
  v_add_f32 v116, s68, v116
  v_cvt_pk_bf16_f32 v116, v116, v116
  v_and_b32 v116, 0xffff0000, v116
  v_sqrt_f32 v116, v116
  s_nop 0
  v_cvt_pk_bf16_f32 v116, v116, v116
  v_and_b32 v116, 0xffff0000, v116
  v_rcp_f32 v122, v116
  s_nop 0
  v_mul_f32 v124, v120, v122
  v_sub_f32 v124, 0, v124
  v_add_u32 v6, 0, v128
  v_and_b32 v7, 15, v6
  v_xor_b32 v8, v3, v7
  v_add_u32 v9, 8, v3
  v_xor_b32 v9, v9, v7
  v_mul_u32_u24 v7, 1280, v6
  v_lshl_add_u32 v14, v8, 4, v7
  v_lshl_add_u32 v15, v9, 4, v7
  v_lshlrev_b32 v96, 16, v16
  v_and_b32 v97, 0xffff0000, v16
  v_lshlrev_b32 v98, 16, v17
  v_and_b32 v99, 0xffff0000, v17
  v_lshlrev_b32 v100, 16, v18
  v_and_b32 v101, 0xffff0000, v18
  v_lshlrev_b32 v102, 16, v19
  v_and_b32 v103, 0xffff0000, v19
  v_pk_fma_f32 v[96:97], v[96:97], v[122:123], v[124:125] op_sel_hi:[1,0,0]
  v_pk_fma_f32 v[98:99], v[98:99], v[122:123], v[124:125] op_sel_hi:[1,0,0]
  v_pk_fma_f32 v[100:101], v[100:101], v[122:123], v[124:125] op_sel_hi:[1,0,0]
  v_pk_fma_f32 v[102:103], v[102:103], v[122:123], v[124:125] op_sel_hi:[1,0,0]
  v_cvt_pk_bf16_f32 v16, v96, v97
  v_cvt_pk_bf16_f32 v17, v98, v99
  v_cvt_pk_bf16_f32 v18, v100, v101
  v_cvt_pk_bf16_f32 v19, v102, v103
  ds_write_b128 v14, v[16:19] offset:0
  v_lshlrev_b32 v104, 16, v20
  v_and_b32 v105, 0xffff0000, v20
  v_lshlrev_b32 v106, 16, v21
  v_and_b32 v107, 0xffff0000, v21
  v_lshlrev_b32 v108, 16, v22
  v_and_b32 v109, 0xffff0000, v22
  v_lshlrev_b32 v110, 16, v23
  v_and_b32 v111, 0xffff0000, v23
  v_pk_fma_f32 v[104:105], v[104:105], v[122:123], v[124:125] op_sel_hi:[1,0,0]
  v_pk_fma_f32 v[106:107], v[106:107], v[122:123], v[124:125] op_sel_hi:[1,0,0]
  v_pk_fma_f32 v[108:109], v[108:109], v[122:123], v[124:125] op_sel_hi:[1,0,0]
  v_pk_fma_f32 v[110:111], v[110:111], v[122:123], v[124:125] op_sel_hi:[1,0,0]
  v_cvt_pk_bf16_f32 v20, v104, v105
  v_cvt_pk_bf16_f32 v21, v106, v107
  v_cvt_pk_bf16_f32 v22, v108, v109
  v_cvt_pk_bf16_f32 v23, v110, v111
  ds_write_b128 v15, v[20:23] offset:0
  v_lshlrev_b32 v96, 16, v24
  v_and_b32 v97, 0xffff0000, v24
  v_lshlrev_b32 v98, 16, v25
  v_and_b32 v99, 0xffff0000, v25
  v_lshlrev_b32 v100, 16, v26
  v_and_b32 v101, 0xffff0000, v26
  v_lshlrev_b32 v102, 16, v27
  v_and_b32 v103, 0xffff0000, v27
  v_pk_fma_f32 v[96:97], v[96:97], v[122:123], v[124:125] op_sel_hi:[1,0,0]
  v_pk_fma_f32 v[98:99], v[98:99], v[122:123], v[124:125] op_sel_hi:[1,0,0]
  v_pk_fma_f32 v[100:101], v[100:101], v[122:123], v[124:125] op_sel_hi:[1,0,0]
  v_pk_fma_f32 v[102:103], v[102:103], v[122:123], v[124:125] op_sel_hi:[1,0,0]
  v_cvt_pk_bf16_f32 v24, v96, v97
  v_cvt_pk_bf16_f32 v25, v98, v99
  v_cvt_pk_bf16_f32 v26, v100, v101
  v_cvt_pk_bf16_f32 v27, v102, v103
  ds_write_b128 v14, v[24:27] offset:256
  v_lshlrev_b32 v104, 16, v28
  v_and_b32 v105, 0xffff0000, v28
  v_lshlrev_b32 v106, 16, v29
  v_and_b32 v107, 0xffff0000, v29
  v_lshlrev_b32 v108, 16, v30
  v_and_b32 v109, 0xffff0000, v30
  v_lshlrev_b32 v110, 16, v31
  v_and_b32 v111, 0xffff0000, v31
  v_pk_fma_f32 v[104:105], v[104:105], v[122:123], v[124:125] op_sel_hi:[1,0,0]
  v_pk_fma_f32 v[106:107], v[106:107], v[122:123], v[124:125] op_sel_hi:[1,0,0]
  v_pk_fma_f32 v[108:109], v[108:109], v[122:123], v[124:125] op_sel_hi:[1,0,0]
  v_pk_fma_f32 v[110:111], v[110:111], v[122:123], v[124:125] op_sel_hi:[1,0,0]
  v_cvt_pk_bf16_f32 v28, v104, v105
  v_cvt_pk_bf16_f32 v29, v106, v107
  v_cvt_pk_bf16_f32 v30, v108, v109
  v_cvt_pk_bf16_f32 v31, v110, v111
  ds_write_b128 v15, v[28:31] offset:256
  v_lshlrev_b32 v96, 16, v32
  v_and_b32 v97, 0xffff0000, v32
  v_lshlrev_b32 v98, 16, v33
  v_and_b32 v99, 0xffff0000, v33
  v_lshlrev_b32 v100, 16, v34
  v_and_b32 v101, 0xffff0000, v34
  v_lshlrev_b32 v102, 16, v35
  v_and_b32 v103, 0xffff0000, v35
  v_pk_fma_f32 v[96:97], v[96:97], v[122:123], v[124:125] op_sel_hi:[1,0,0]
  v_pk_fma_f32 v[98:99], v[98:99], v[122:123], v[124:125] op_sel_hi:[1,0,0]
  v_pk_fma_f32 v[100:101], v[100:101], v[122:123], v[124:125] op_sel_hi:[1,0,0]
  v_pk_fma_f32 v[102:103], v[102:103], v[122:123], v[124:125] op_sel_hi:[1,0,0]
  v_cvt_pk_bf16_f32 v32, v96, v97
  v_cvt_pk_bf16_f32 v33, v98, v99
  v_cvt_pk_bf16_f32 v34, v100, v101
  v_cvt_pk_bf16_f32 v35, v102, v103
  ds_write_b128 v14, v[32:35] offset:512
  v_lshlrev_b32 v104, 16, v36
  v_and_b32 v105, 0xffff0000, v36
  v_lshlrev_b32 v106, 16, v37
  v_and_b32 v107, 0xffff0000, v37
  v_lshlrev_b32 v108, 16, v38
  v_and_b32 v109, 0xffff0000, v38
  v_lshlrev_b32 v110, 16, v39
  v_and_b32 v111, 0xffff0000, v39
  v_pk_fma_f32 v[104:105], v[104:105], v[122:123], v[124:125] op_sel_hi:[1,0,0]
  v_pk_fma_f32 v[106:107], v[106:107], v[122:123], v[124:125] op_sel_hi:[1,0,0]
  v_pk_fma_f32 v[108:109], v[108:109], v[122:123], v[124:125] op_sel_hi:[1,0,0]
  v_pk_fma_f32 v[110:111], v[110:111], v[122:123], v[124:125] op_sel_hi:[1,0,0]
  v_cvt_pk_bf16_f32 v36, v104, v105
  v_cvt_pk_bf16_f32 v37, v106, v107
  v_cvt_pk_bf16_f32 v38, v108, v109
  v_cvt_pk_bf16_f32 v39, v110, v111
  ds_write_b128 v15, v[36:39] offset:512
  v_lshlrev_b32 v96, 16, v40
  v_and_b32 v97, 0xffff0000, v40
  v_lshlrev_b32 v98, 16, v41
  v_and_b32 v99, 0xffff0000, v41
  v_lshlrev_b32 v100, 16, v42
  v_and_b32 v101, 0xffff0000, v42
  v_lshlrev_b32 v102, 16, v43
  v_and_b32 v103, 0xffff0000, v43
  v_pk_fma_f32 v[96:97], v[96:97], v[122:123], v[124:125] op_sel_hi:[1,0,0]
  v_pk_fma_f32 v[98:99], v[98:99], v[122:123], v[124:125] op_sel_hi:[1,0,0]
  v_pk_fma_f32 v[100:101], v[100:101], v[122:123], v[124:125] op_sel_hi:[1,0,0]
  v_pk_fma_f32 v[102:103], v[102:103], v[122:123], v[124:125] op_sel_hi:[1,0,0]
  v_cvt_pk_bf16_f32 v40, v96, v97
  v_cvt_pk_bf16_f32 v41, v98, v99
  v_cvt_pk_bf16_f32 v42, v100, v101
  v_cvt_pk_bf16_f32 v43, v102, v103
  ds_write_b128 v14, v[40:43] offset:768
  v_lshlrev_b32 v104, 16, v44
  v_and_b32 v105, 0xffff0000, v44
  v_lshlrev_b32 v106, 16, v45
  v_and_b32 v107, 0xffff0000, v45
  v_lshlrev_b32 v108, 16, v46
  v_and_b32 v109, 0xffff0000, v46
  v_lshlrev_b32 v110, 16, v47
  v_and_b32 v111, 0xffff0000, v47
  v_pk_fma_f32 v[104:105], v[104:105], v[122:123], v[124:125] op_sel_hi:[1,0,0]
  v_pk_fma_f32 v[106:107], v[106:107], v[122:123], v[124:125] op_sel_hi:[1,0,0]
  v_pk_fma_f32 v[108:109], v[108:109], v[122:123], v[124:125] op_sel_hi:[1,0,0]
  v_pk_fma_f32 v[110:111], v[110:111], v[122:123], v[124:125] op_sel_hi:[1,0,0]
  v_cvt_pk_bf16_f32 v44, v104, v105
  v_cvt_pk_bf16_f32 v45, v106, v107
  v_cvt_pk_bf16_f32 v46, v108, v109
  v_cvt_pk_bf16_f32 v47, v110, v111
  ds_write_b128 v15, v[44:47] offset:768
  v_lshlrev_b32 v96, 16, v48
  v_and_b32 v97, 0xffff0000, v48
  v_lshlrev_b32 v98, 16, v49
  v_and_b32 v99, 0xffff0000, v49
  v_lshlrev_b32 v100, 16, v50
  v_and_b32 v101, 0xffff0000, v50
  v_lshlrev_b32 v102, 16, v51
  v_and_b32 v103, 0xffff0000, v51
  v_pk_fma_f32 v[96:97], v[96:97], v[122:123], v[124:125] op_sel_hi:[1,0,0]
  v_pk_fma_f32 v[98:99], v[98:99], v[122:123], v[124:125] op_sel_hi:[1,0,0]
  v_pk_fma_f32 v[100:101], v[100:101], v[122:123], v[124:125] op_sel_hi:[1,0,0]
  v_pk_fma_f32 v[102:103], v[102:103], v[122:123], v[124:125] op_sel_hi:[1,0,0]
  v_cvt_pk_bf16_f32 v48, v96, v97
  v_cvt_pk_bf16_f32 v49, v98, v99
  v_cvt_pk_bf16_f32 v50, v100, v101
  v_cvt_pk_bf16_f32 v51, v102, v103
  ds_write_b128 v14, v[48:51] offset:1024
  v_lshlrev_b32 v104, 16, v52
  v_and_b32 v105, 0xffff0000, v52
  v_lshlrev_b32 v106, 16, v53
  v_and_b32 v107, 0xffff0000, v53
  v_lshlrev_b32 v108, 16, v54
  v_and_b32 v109, 0xffff0000, v54
  v_lshlrev_b32 v110, 16, v55
  v_and_b32 v111, 0xffff0000, v55
  v_pk_fma_f32 v[104:105], v[104:105], v[122:123], v[124:125] op_sel_hi:[1,0,0]
  v_pk_fma_f32 v[106:107], v[106:107], v[122:123], v[124:125] op_sel_hi:[1,0,0]
  v_pk_fma_f32 v[108:109], v[108:109], v[122:123], v[124:125] op_sel_hi:[1,0,0]
  v_pk_fma_f32 v[110:111], v[110:111], v[122:123], v[124:125] op_sel_hi:[1,0,0]
  v_cvt_pk_bf16_f32 v52, v104, v105
  v_cvt_pk_bf16_f32 v53, v106, v107
  v_cvt_pk_bf16_f32 v54, v108, v109
  v_cvt_pk_bf16_f32 v55, v110, v111
  ds_write_b128 v15, v[52:55] offset:1024
  s_waitcnt vmcnt(0)
  v_dot2_f32_bf16 v112, v56, s69, 0
  v_dot2_f32_bf16 v116, v56, v56, 0
  v_dot2_f32_bf16 v113, v57, s69, 0
  v_dot2_f32_bf16 v117, v57, v57, 0
  v_dot2_f32_bf16 v112, v58, s69, v112
  v_dot2_f32_bf16 v116, v58, v58, v116
  v_dot2_f32_bf16 v113, v59, s69, v113
  v_dot2_f32_bf16 v117, v59, v59, v117
  v_dot2_f32_bf16 v112, v60, s69, v112
  v_dot2_f32_bf16 v116, v60, v60, v116
  v_dot2_f32_bf16 v113, v61, s69, v113
  v_dot2_f32_bf16 v117, v61, v61, v117
  v_dot2_f32_bf16 v112, v62, s69, v112
  v_dot2_f32_bf16 v116, v62, v62, v116
  v_dot2_f32_bf16 v113, v63, s69, v113
  v_dot2_f32_bf16 v117, v63, v63, v117
  v_dot2_f32_bf16 v112, v64, s69, v112
  v_dot2_f32_bf16 v116, v64, v64, v116
  v_dot2_f32_bf16 v113, v65, s69, v113
  v_dot2_f32_bf16 v117, v65, v65, v117
  v_dot2_f32_bf16 v112, v66, s69, v112
  v_dot2_f32_bf16 v116, v66, v66, v116
  v_dot2_f32_bf16 v113, v67, s69, v113
  v_dot2_f32_bf16 v117, v67, v67, v117
  v_dot2_f32_bf16 v112, v68, s69, v112
  v_dot2_f32_bf16 v116, v68, v68, v116
  v_dot2_f32_bf16 v113, v69, s69, v113
  v_dot2_f32_bf16 v117, v69, v69, v117
  v_dot2_f32_bf16 v112, v70, s69, v112
  v_dot2_f32_bf16 v116, v70, v70, v116
  v_dot2_f32_bf16 v113, v71, s69, v113
  v_dot2_f32_bf16 v117, v71, v71, v117
  v_dot2_f32_bf16 v112, v72, s69, v112
  v_dot2_f32_bf16 v116, v72, v72, v116
  v_dot2_f32_bf16 v113, v73, s69, v113
  v_dot2_f32_bf16 v117, v73, v73, v117
  v_dot2_f32_bf16 v112, v74, s69, v112
  v_dot2_f32_bf16 v116, v74, v74, v116
  v_dot2_f32_bf16 v113, v75, s69, v113
  v_dot2_f32_bf16 v117, v75, v75, v117
  v_dot2_f32_bf16 v112, v76, s69, v112
  v_dot2_f32_bf16 v116, v76, v76, v116
  v_dot2_f32_bf16 v113, v77, s69, v113
  v_dot2_f32_bf16 v117, v77, v77, v117
  v_dot2_f32_bf16 v112, v78, s69, v112
  v_dot2_f32_bf16 v116, v78, v78, v116
  v_dot2_f32_bf16 v113, v79, s69, v113
  v_dot2_f32_bf16 v117, v79, v79, v117
  v_dot2_f32_bf16 v112, v80, s69, v112
  v_dot2_f32_bf16 v116, v80, v80, v116
  v_dot2_f32_bf16 v113, v81, s69, v113
  v_dot2_f32_bf16 v117, v81, v81, v117
  v_dot2_f32_bf16 v112, v82, s69, v112
  v_dot2_f32_bf16 v116, v82, v82, v116
  v_dot2_f32_bf16 v113, v83, s69, v113
  v_dot2_f32_bf16 v117, v83, v83, v117
  v_dot2_f32_bf16 v112, v84, s69, v112
  v_dot2_f32_bf16 v116, v84, v84, v116
  v_dot2_f32_bf16 v113, v85, s69, v113
  v_dot2_f32_bf16 v117, v85, v85, v117
  v_dot2_f32_bf16 v112, v86, s69, v112
  v_dot2_f32_bf16 v116, v86, v86, v116
  v_dot2_f32_bf16 v113, v87, s69, v113
  v_dot2_f32_bf16 v117, v87, v87, v117
  v_dot2_f32_bf16 v112, v88, s69, v112
  v_dot2_f32_bf16 v116, v88, v88, v116
  v_dot2_f32_bf16 v113, v89, s69, v113
  v_dot2_f32_bf16 v117, v89, v89, v117
  v_dot2_f32_bf16 v112, v90, s69, v112
  v_dot2_f32_bf16 v116, v90, v90, v116
  v_dot2_f32_bf16 v113, v91, s69, v113
  v_dot2_f32_bf16 v117, v91, v91, v117
  v_dot2_f32_bf16 v112, v92, s69, v112
  v_dot2_f32_bf16 v116, v92, v92, v116
  v_dot2_f32_bf16 v113, v93, s69, v113
  v_dot2_f32_bf16 v117, v93, v93, v117
  v_dot2_f32_bf16 v112, v94, s69, v112
  v_dot2_f32_bf16 v116, v94, v94, v116
  v_dot2_f32_bf16 v113, v95, s69, v113
  v_dot2_f32_bf16 v117, v95, v95, v117
  s_nop 2
  v_add_f32 v112, v112, v113
  v_add_f32 v116, v116, v117
  s_nop 0
  v_add_f32_dpp v112, v112, v112 quad_perm:[1,0,3,2] row_mask:0xf bank_mask:0xf
  v_add_f32_dpp v116, v116, v116 quad_perm:[1,0,3,2] row_mask:0xf bank_mask:0xf
  s_nop 0
  v_add_f32_dpp v112, v112, v112 quad_perm:[2,3,0,1] row_mask:0xf bank_mask:0xf
  v_add_f32_dpp v116, v116, v116 quad_perm:[2,3,0,1] row_mask:0xf bank_mask:0xf
  s_nop 0
  v_add_f32_dpp v112, v112, v112 row_half_mirror row_mask:0xf bank_mask:0xf
  v_add_f32_dpp v116, v116, v116 row_half_mirror row_mask:0xf bank_mask:0xf
  s_nop 0
  v_mul_f32 v120, s67, v112
  v_mul_f32 v116, s67, v116
  v_fma_f32 v116, -v120, v120, v116
  v_max_f32 v116, 0, v116
  v_cvt_pk_bf16_f32 v120, v120, v120
  v_cvt_pk_bf16_f32 v116, v116, v116
  v_and_b32 v120, 0xffff0000, v120
  v_and_b32 v116, 0xffff0000, v116
  v_add_f32 v116, s68, v116
  v_cvt_pk_bf16_f32 v116, v116, v116
  v_and_b32 v116, 0xffff0000, v116
  v_sqrt_f32 v116, v116
  s_nop 0
  v_cvt_pk_bf16_f32 v116, v116, v116
  v_and_b32 v116, 0xffff0000, v116
  v_rcp_f32 v122, v116
  s_nop 0
  v_mul_f32 v124, v120, v122
  v_sub_f32 v124, 0, v124
  v_add_u32 v6, 8, v128
  v_and_b32 v7, 15, v6
  v_xor_b32 v8, v3, v7
  v_add_u32 v9, 8, v3
  v_xor_b32 v9, v9, v7
  v_mul_u32_u24 v7, 1280, v6
  v_lshl_add_u32 v14, v8, 4, v7
  v_lshl_add_u32 v15, v9, 4, v7
  v_lshlrev_b32 v96, 16, v56
  v_and_b32 v97, 0xffff0000, v56
  v_lshlrev_b32 v98, 16, v57
  v_and_b32 v99, 0xffff0000, v57
  v_lshlrev_b32 v100, 16, v58
  v_and_b32 v101, 0xffff0000, v58
  v_lshlrev_b32 v102, 16, v59
  v_and_b32 v103, 0xffff0000, v59
  v_pk_fma_f32 v[96:97], v[96:97], v[122:123], v[124:125] op_sel_hi:[1,0,0]
  v_pk_fma_f32 v[98:99], v[98:99], v[122:123], v[124:125] op_sel_hi:[1,0,0]
  v_pk_fma_f32 v[100:101], v[100:101], v[122:123], v[124:125] op_sel_hi:[1,0,0]
  v_pk_fma_f32 v[102:103], v[102:103], v[122:123], v[124:125] op_sel_hi:[1,0,0]
  v_cvt_pk_bf16_f32 v56, v96, v97
  v_cvt_pk_bf16_f32 v57, v98, v99
  v_cvt_pk_bf16_f32 v58, v100, v101
  v_cvt_pk_bf16_f32 v59, v102, v103
  ds_write_b128 v14, v[56:59] offset:0
  v_lshlrev_b32 v104, 16, v60
  v_and_b32 v105, 0xffff0000, v60
  v_lshlrev_b32 v106, 16, v61
  v_and_b32 v107, 0xffff0000, v61
  v_lshlrev_b32 v108, 16, v62
  v_and_b32 v109, 0xffff0000, v62
  v_lshlrev_b32 v110, 16, v63
  v_and_b32 v111, 0xffff0000, v63
  v_pk_fma_f32 v[104:105], v[104:105], v[122:123], v[124:125] op_sel_hi:[1,0,0]
  v_pk_fma_f32 v[106:107], v[106:107], v[122:123], v[124:125] op_sel_hi:[1,0,0]
  v_pk_fma_f32 v[108:109], v[108:109], v[122:123], v[124:125] op_sel_hi:[1,0,0]
  v_pk_fma_f32 v[110:111], v[110:111], v[122:123], v[124:125] op_sel_hi:[1,0,0]
  v_cvt_pk_bf16_f32 v60, v104, v105
  v_cvt_pk_bf16_f32 v61, v106, v107
  v_cvt_pk_bf16_f32 v62, v108, v109
  v_cvt_pk_bf16_f32 v63, v110, v111
  ds_write_b128 v15, v[60:63] offset:0
  v_lshlrev_b32 v96, 16, v64
  v_and_b32 v97, 0xffff0000, v64
  v_lshlrev_b32 v98, 16, v65
  v_and_b32 v99, 0xffff0000, v65
  v_lshlrev_b32 v100, 16, v66
  v_and_b32 v101, 0xffff0000, v66
  v_lshlrev_b32 v102, 16, v67
  v_and_b32 v103, 0xffff0000, v67
  v_pk_fma_f32 v[96:97], v[96:97], v[122:123], v[124:125] op_sel_hi:[1,0,0]
  v_pk_fma_f32 v[98:99], v[98:99], v[122:123], v[124:125] op_sel_hi:[1,0,0]
  v_pk_fma_f32 v[100:101], v[100:101], v[122:123], v[124:125] op_sel_hi:[1,0,0]
  v_pk_fma_f32 v[102:103], v[102:103], v[122:123], v[124:125] op_sel_hi:[1,0,0]
  v_cvt_pk_bf16_f32 v64, v96, v97
  v_cvt_pk_bf16_f32 v65, v98, v99
  v_cvt_pk_bf16_f32 v66, v100, v101
  v_cvt_pk_bf16_f32 v67, v102, v103
  ds_write_b128 v14, v[64:67] offset:256
  v_lshlrev_b32 v104, 16, v68
  v_and_b32 v105, 0xffff0000, v68
  v_lshlrev_b32 v106, 16, v69
  v_and_b32 v107, 0xffff0000, v69
  v_lshlrev_b32 v108, 16, v70
  v_and_b32 v109, 0xffff0000, v70
  v_lshlrev_b32 v110, 16, v71
  v_and_b32 v111, 0xffff0000, v71
  v_pk_fma_f32 v[104:105], v[104:105], v[122:123], v[124:125] op_sel_hi:[1,0,0]
  v_pk_fma_f32 v[106:107], v[106:107], v[122:123], v[124:125] op_sel_hi:[1,0,0]
  v_pk_fma_f32 v[108:109], v[108:109], v[122:123], v[124:125] op_sel_hi:[1,0,0]
  v_pk_fma_f32 v[110:111], v[110:111], v[122:123], v[124:125] op_sel_hi:[1,0,0]
  v_cvt_pk_bf16_f32 v68, v104, v105
  v_cvt_pk_bf16_f32 v69, v106, v107
  v_cvt_pk_bf16_f32 v70, v108, v109
  v_cvt_pk_bf16_f32 v71, v110, v111
  ds_write_b128 v15, v[68:71] offset:256
  v_lshlrev_b32 v96, 16, v72
  v_and_b32 v97, 0xffff0000, v72
  v_lshlrev_b32 v98, 16, v73
  v_and_b32 v99, 0xffff0000, v73
  v_lshlrev_b32 v100, 16, v74
  v_and_b32 v101, 0xffff0000, v74
  v_lshlrev_b32 v102, 16, v75
  v_and_b32 v103, 0xffff0000, v75
  v_pk_fma_f32 v[96:97], v[96:97], v[122:123], v[124:125] op_sel_hi:[1,0,0]
  v_pk_fma_f32 v[98:99], v[98:99], v[122:123], v[124:125] op_sel_hi:[1,0,0]
  v_pk_fma_f32 v[100:101], v[100:101], v[122:123], v[124:125] op_sel_hi:[1,0,0]
  v_pk_fma_f32 v[102:103], v[102:103], v[122:123], v[124:125] op_sel_hi:[1,0,0]
  v_cvt_pk_bf16_f32 v72, v96, v97
  v_cvt_pk_bf16_f32 v73, v98, v99
  v_cvt_pk_bf16_f32 v74, v100, v101
  v_cvt_pk_bf16_f32 v75, v102, v103
  ds_write_b128 v14, v[72:75] offset:512
  v_lshlrev_b32 v104, 16, v76
  v_and_b32 v105, 0xffff0000, v76
  v_lshlrev_b32 v106, 16, v77
  v_and_b32 v107, 0xffff0000, v77
  v_lshlrev_b32 v108, 16, v78
  v_and_b32 v109, 0xffff0000, v78
  v_lshlrev_b32 v110, 16, v79
  v_and_b32 v111, 0xffff0000, v79
  v_pk_fma_f32 v[104:105], v[104:105], v[122:123], v[124:125] op_sel_hi:[1,0,0]
  v_pk_fma_f32 v[106:107], v[106:107], v[122:123], v[124:125] op_sel_hi:[1,0,0]
  v_pk_fma_f32 v[108:109], v[108:109], v[122:123], v[124:125] op_sel_hi:[1,0,0]
  v_pk_fma_f32 v[110:111], v[110:111], v[122:123], v[124:125] op_sel_hi:[1,0,0]
  v_cvt_pk_bf16_f32 v76, v104, v105
  v_cvt_pk_bf16_f32 v77, v106, v107
  v_cvt_pk_bf16_f32 v78, v108, v109
  v_cvt_pk_bf16_f32 v79, v110, v111
  ds_write_b128 v15, v[76:79] offset:512
  v_lshlrev_b32 v96, 16, v80
  v_and_b32 v97, 0xffff0000, v80
  v_lshlrev_b32 v98, 16, v81
  v_and_b32 v99, 0xffff0000, v81
  v_lshlrev_b32 v100, 16, v82
  v_and_b32 v101, 0xffff0000, v82
  v_lshlrev_b32 v102, 16, v83
  v_and_b32 v103, 0xffff0000, v83
  v_pk_fma_f32 v[96:97], v[96:97], v[122:123], v[124:125] op_sel_hi:[1,0,0]
  v_pk_fma_f32 v[98:99], v[98:99], v[122:123], v[124:125] op_sel_hi:[1,0,0]
  v_pk_fma_f32 v[100:101], v[100:101], v[122:123], v[124:125] op_sel_hi:[1,0,0]
  v_pk_fma_f32 v[102:103], v[102:103], v[122:123], v[124:125] op_sel_hi:[1,0,0]
  v_cvt_pk_bf16_f32 v80, v96, v97
  v_cvt_pk_bf16_f32 v81, v98, v99
  v_cvt_pk_bf16_f32 v82, v100, v101
  v_cvt_pk_bf16_f32 v83, v102, v103
  ds_write_b128 v14, v[80:83] offset:768
  v_lshlrev_b32 v104, 16, v84
  v_and_b32 v105, 0xffff0000, v84
  v_lshlrev_b32 v106, 16, v85
  v_and_b32 v107, 0xffff0000, v85
  v_lshlrev_b32 v108, 16, v86
  v_and_b32 v109, 0xffff0000, v86
  v_lshlrev_b32 v110, 16, v87
  v_and_b32 v111, 0xffff0000, v87
  v_pk_fma_f32 v[104:105], v[104:105], v[122:123], v[124:125] op_sel_hi:[1,0,0]
  v_pk_fma_f32 v[106:107], v[106:107], v[122:123], v[124:125] op_sel_hi:[1,0,0]
  v_pk_fma_f32 v[108:109], v[108:109], v[122:123], v[124:125] op_sel_hi:[1,0,0]
  v_pk_fma_f32 v[110:111], v[110:111], v[122:123], v[124:125] op_sel_hi:[1,0,0]
  v_cvt_pk_bf16_f32 v84, v104, v105
  v_cvt_pk_bf16_f32 v85, v106, v107
  v_cvt_pk_bf16_f32 v86, v108, v109
  v_cvt_pk_bf16_f32 v87, v110, v111
  ds_write_b128 v15, v[84:87] offset:768
  v_lshlrev_b32 v96, 16, v88
  v_and_b32 v97, 0xffff0000, v88
  v_lshlrev_b32 v98, 16, v89
  v_and_b32 v99, 0xffff0000, v89
  v_lshlrev_b32 v100, 16, v90
  v_and_b32 v101, 0xffff0000, v90
  v_lshlrev_b32 v102, 16, v91
  v_and_b32 v103, 0xffff0000, v91
  v_pk_fma_f32 v[96:97], v[96:97], v[122:123], v[124:125] op_sel_hi:[1,0,0]
  v_pk_fma_f32 v[98:99], v[98:99], v[122:123], v[124:125] op_sel_hi:[1,0,0]
  v_pk_fma_f32 v[100:101], v[100:101], v[122:123], v[124:125] op_sel_hi:[1,0,0]
  v_pk_fma_f32 v[102:103], v[102:103], v[122:123], v[124:125] op_sel_hi:[1,0,0]
  v_cvt_pk_bf16_f32 v88, v96, v97
  v_cvt_pk_bf16_f32 v89, v98, v99
  v_cvt_pk_bf16_f32 v90, v100, v101
  v_cvt_pk_bf16_f32 v91, v102, v103
  ds_write_b128 v14, v[88:91] offset:1024
  v_lshlrev_b32 v104, 16, v92
  v_and_b32 v105, 0xffff0000, v92
  v_lshlrev_b32 v106, 16, v93
  v_and_b32 v107, 0xffff0000, v93
  v_lshlrev_b32 v108, 16, v94
  v_and_b32 v109, 0xffff0000, v94
  v_lshlrev_b32 v110, 16, v95
  v_and_b32 v111, 0xffff0000, v95
  v_pk_fma_f32 v[104:105], v[104:105], v[122:123], v[124:125] op_sel_hi:[1,0,0]
  v_pk_fma_f32 v[106:107], v[106:107], v[122:123], v[124:125] op_sel_hi:[1,0,0]
  v_pk_fma_f32 v[108:109], v[108:109], v[122:123], v[124:125] op_sel_hi:[1,0,0]
  v_pk_fma_f32 v[110:111], v[110:111], v[122:123], v[124:125] op_sel_hi:[1,0,0]
  v_cvt_pk_bf16_f32 v92, v104, v105
  v_cvt_pk_bf16_f32 v93, v106, v107
  v_cvt_pk_bf16_f32 v94, v108, v109
  v_cvt_pk_bf16_f32 v95, v110, v111
  ds_write_b128 v15, v[92:95] offset:1024
  s_waitcnt lgkmcnt(0)
  s_barrier
  ds_read_b128 v[16:19], v160 offset:0
  ds_read_b128 v[20:23], v160 offset:20480
  ds_read_b128 v[24:27], v160 offset:40960
  ds_read_b128 v[28:31], v160 offset:61440
  ds_read_b64_tr_b16 v[32:33], v164 offset:0
  ds_read_b64_tr_b16 v[34:35], v164 offset:2048
  ds_read_b64_tr_b16 v[36:37], v165 offset:0
  ds_read_b64_tr_b16 v[38:39], v165 offset:2048
  ds_read_b64_tr_b16 v[40:41], v166 offset:0
  ds_read_b64_tr_b16 v[42:43], v166 offset:2048
  ds_read_b64_tr_b16 v[44:45], v167 offset:0
  ds_read_b64_tr_b16 v[46:47], v167 offset:2048
  s_mov_b32 s62, 5
  s_waitcnt lgkmcnt(0)
L_N_cloop:
  s_barrier
  v_mfma_f32_16x16x32_bf16 v[176:179], v[32:35], v[16:19], v[176:179]
  ds_read_b128 v[48:51], v161 offset:0
  v_mfma_f32_16x16x32_bf16 v[180:183], v[32:35], v[20:23], v[180:183]
  ds_read_b128 v[52:55], v161 offset:20480
  v_mfma_f32_16x16x32_bf16 v[184:187], v[32:35], v[24:27], v[184:187]
  ds_read_b128 v[56:59], v161 offset:40960
  v_mfma_f32_16x16x32_bf16 v[188:191], v[32:35], v[28:31], v[188:191]
  ds_read_b128 v[60:63], v161 offset:61440
  v_mfma_f32_16x16x32_bf16 v[192:195], v[36:39], v[16:19], v[192:195]
  ds_read_b64_tr_b16 v[64:65], v164 offset:16384
  v_mfma_f32_16x16x32_bf16 v[196:199], v[36:39], v[20:23], v[196:199]
  ds_read_b64_tr_b16 v[66:67], v164 offset:18432
  v_mfma_f32_16x16x32_bf16 v[200:203], v[36:39], v[24:27], v[200:203]
  ds_read_b64_tr_b16 v[68:69], v165 offset:16384
  v_mfma_f32_16x16x32_bf16 v[204:207], v[36:39], v[28:31], v[204:207]
  ds_read_b64_tr_b16 v[70:71], v165 offset:18432
  v_mfma_f32_16x16x32_bf16 v[208:211], v[40:43], v[16:19], v[208:211]
  ds_read_b64_tr_b16 v[72:73], v166 offset:16384
  v_mfma_f32_16x16x32_bf16 v[212:215], v[40:43], v[20:23], v[212:215]
  ds_read_b64_tr_b16 v[74:75], v166 offset:18432
  v_mfma_f32_16x16x32_bf16 v[216:219], v[40:43], v[24:27], v[216:219]
  ds_read_b64_tr_b16 v[76:77], v167 offset:16384
  v_mfma_f32_16x16x32_bf16 v[220:223], v[40:43], v[28:31], v[220:223]
  ds_read_b64_tr_b16 v[78:79], v167 offset:18432
  v_mfma_f32_16x16x32_bf16 v[224:227], v[44:47], v[16:19], v[224:227]
  v_mfma_f32_16x16x32_bf16 v[228:231], v[44:47], v[20:23], v[228:231]
  v_mfma_f32_16x16x32_bf16 v[232:235], v[44:47], v[24:27], v[232:235]
  v_mfma_f32_16x16x32_bf16 v[236:239], v[44:47], v[28:31], v[236:239]
  s_waitcnt lgkmcnt(0)
  s_barrier
  v_mfma_f32_16x16x32_bf16 v[176:179], v[64:67], v[48:51], v[176:179]
  ds_read_b128 v[16:19], v162 offset:0
  v_mfma_f32_16x16x32_bf16 v[180:183], v[64:67], v[52:55], v[180:183]
  ds_read_b128 v[20:23], v162 offset:20480
  v_mfma_f32_16x16x32_bf16 v[184:187], v[64:67], v[56:59], v[184:187]
  ds_read_b128 v[24:27], v162 offset:40960
  v_mfma_f32_16x16x32_bf16 v[188:191], v[64:67], v[60:63], v[188:191]
  ds_read_b128 v[28:31], v162 offset:61440
  v_mfma_f32_16x16x32_bf16 v[192:195], v[68:71], v[48:51], v[192:195]
  ds_read_b64_tr_b16 v[32:33], v164 offset:32768
  v_mfma_f32_16x16x32_bf16 v[196:199], v[68:71], v[52:55], v[196:199]
  ds_read_b64_tr_b16 v[34:35], v164 offset:34816
  v_mfma_f32_16x16x32_bf16 v[200:203], v[68:71], v[56:59], v[200:203]
  ds_read_b64_tr_b16 v[36:37], v165 offset:32768
  v_mfma_f32_16x16x32_bf16 v[204:207], v[68:71], v[60:63], v[204:207]
  ds_read_b64_tr_b16 v[38:39], v165 offset:34816
  v_mfma_f32_16x16x32_bf16 v[208:211], v[72:75], v[48:51], v[208:211]
  ds_read_b64_tr_b16 v[40:41], v166 offset:32768
  v_mfma_f32_16x16x32_bf16 v[212:215], v[72:75], v[52:55], v[212:215]
  ds_read_b64_tr_b16 v[42:43], v166 offset:34816
  v_mfma_f32_16x16x32_bf16 v[216:219], v[72:75], v[56:59], v[216:219]
  ds_read_b64_tr_b16 v[44:45], v167 offset:32768
  v_mfma_f32_16x16x32_bf16 v[220:223], v[72:75], v[60:63], v[220:223]
  ds_read_b64_tr_b16 v[46:47], v167 offset:34816
  v_mfma_f32_16x16x32_bf16 v[224:227], v[76:79], v[48:51], v[224:227]
  v_mfma_f32_16x16x32_bf16 v[228:231], v[76:79], v[52:55], v[228:231]
  v_mfma_f32_16x16x32_bf16 v[232:235], v[76:79], v[56:59], v[232:235]
  v_mfma_f32_16x16x32_bf16 v[236:239], v[76:79], v[60:63], v[236:239]
  s_waitcnt lgkmcnt(0)
  s_barrier
  v_mfma_f32_16x16x32_bf16 v[176:179], v[32:35], v[16:19], v[176:179]
  ds_read_b128 v[48:51], v163 offset:0
  v_mfma_f32_16x16x32_bf16 v[180:183], v[32:35], v[20:23], v[180:183]
  ds_read_b128 v[52:55], v163 offset:20480
  v_mfma_f32_16x16x32_bf16 v[184:187], v[32:35], v[24:27], v[184:187]
  ds_read_b128 v[56:59], v163 offset:40960
  v_mfma_f32_16x16x32_bf16 v[188:191], v[32:35], v[28:31], v[188:191]
  ds_read_b128 v[60:63], v163 offset:61440
  v_mfma_f32_16x16x32_bf16 v[192:195], v[36:39], v[16:19], v[192:195]
  ds_read_b64_tr_b16 v[64:65], v164 offset:49152
  v_mfma_f32_16x16x32_bf16 v[196:199], v[36:39], v[20:23], v[196:199]
  ds_read_b64_tr_b16 v[66:67], v164 offset:51200
  v_mfma_f32_16x16x32_bf16 v[200:203], v[36:39], v[24:27], v[200:203]
  ds_read_b64_tr_b16 v[68:69], v165 offset:49152
  v_mfma_f32_16x16x32_bf16 v[204:207], v[36:39], v[28:31], v[204:207]
  ds_read_b64_tr_b16 v[70:71], v165 offset:51200
  v_mfma_f32_16x16x32_bf16 v[208:211], v[40:43], v[16:19], v[208:211]
  ds_read_b64_tr_b16 v[72:73], v166 offset:49152
  v_mfma_f32_16x16x32_bf16 v[212:215], v[40:43], v[20:23], v[212:215]
  ds_read_b64_tr_b16 v[74:75], v166 offset:51200
  v_mfma_f32_16x16x32_bf16 v[216:219], v[40:43], v[24:27], v[216:219]
  ds_read_b64_tr_b16 v[76:77], v167 offset:49152
  v_mfma_f32_16x16x32_bf16 v[220:223], v[40:43], v[28:31], v[220:223]
  ds_read_b64_tr_b16 v[78:79], v167 offset:51200
  v_mfma_f32_16x16x32_bf16 v[224:227], v[44:47], v[16:19], v[224:227]
  v_mfma_f32_16x16x32_bf16 v[228:231], v[44:47], v[20:23], v[228:231]
  v_mfma_f32_16x16x32_bf16 v[232:235], v[44:47], v[24:27], v[232:235]
  v_mfma_f32_16x16x32_bf16 v[236:239], v[44:47], v[28:31], v[236:239]
  s_waitcnt lgkmcnt(0)
  s_barrier
  v_mfma_f32_16x16x32_bf16 v[176:179], v[64:67], v[48:51], v[176:179]
  ds_read_b128 v[16:19], v160 offset:256
  v_mfma_f32_16x16x32_bf16 v[180:183], v[64:67], v[52:55], v[180:183]
  ds_read_b128 v[20:23], v160 offset:20736
  v_mfma_f32_16x16x32_bf16 v[184:187], v[64:67], v[56:59], v[184:187]
  ds_read_b128 v[24:27], v160 offset:41216
  v_mfma_f32_16x16x32_bf16 v[188:191], v[64:67], v[60:63], v[188:191]
  ds_read_b128 v[28:31], v160 offset:61696
  v_mfma_f32_16x16x32_bf16 v[192:195], v[68:71], v[48:51], v[192:195]
  ds_read_b64_tr_b16 v[32:33], v164 offset:0
  v_mfma_f32_16x16x32_bf16 v[196:199], v[68:71], v[52:55], v[196:199]
  ds_read_b64_tr_b16 v[34:35], v164 offset:2048
  v_mfma_f32_16x16x32_bf16 v[200:203], v[68:71], v[56:59], v[200:203]
  ds_read_b64_tr_b16 v[36:37], v165 offset:0
  v_mfma_f32_16x16x32_bf16 v[204:207], v[68:71], v[60:63], v[204:207]
  ds_read_b64_tr_b16 v[38:39], v165 offset:2048
  v_mfma_f32_16x16x32_bf16 v[208:211], v[72:75], v[48:51], v[208:211]
  ds_read_b64_tr_b16 v[40:41], v166 offset:0
  v_mfma_f32_16x16x32_bf16 v[212:215], v[72:75], v[52:55], v[212:215]
  ds_read_b64_tr_b16 v[42:43], v166 offset:2048
  v_mfma_f32_16x16x32_bf16 v[216:219], v[72:75], v[56:59], v[216:219]
  ds_read_b64_tr_b16 v[44:45], v167 offset:0
  v_mfma_f32_16x16x32_bf16 v[220:223], v[72:75], v[60:63], v[220:223]
  ds_read_b64_tr_b16 v[46:47], v167 offset:2048
  v_mfma_f32_16x16x32_bf16 v[224:227], v[76:79], v[48:51], v[224:227]
  v_mfma_f32_16x16x32_bf16 v[228:231], v[76:79], v[52:55], v[228:231]
  v_mfma_f32_16x16x32_bf16 v[232:235], v[76:79], v[56:59], v[232:235]
  v_mfma_f32_16x16x32_bf16 v[236:239], v[76:79], v[60:63], v[236:239]
  v_add_u32 v160, 0x100, v160
  v_add_u32 v161, 0x100, v161
  v_add_u32 v162, 0x100, v162
  v_add_u32 v163, 0x100, v163
  s_waitcnt lgkmcnt(0)
  s_sub_u32 s62, s62, 1
  s_cmp_lg_u32 s62, 0
  s_cbranch_scc1 L_N_cloop
  s_mov_b32 s92, s10
  s_mov_b32 s93, s11
  s_mov_b32 s94, 256
  s_mov_b32 s95, 0x00020000
  s_add_u32 s96, s20, 20971520
  s_addc_u32 s97, s21, 0
  s_mov_b32 s98, 262144
  s_mov_b32 s99, 0x00020000
  v_mov_b32 v6, 0
  buffer_load_dword v130, v6, s[92:95], 0 offen sc1
  v_lshlrev_b32 v6, 4, v1
  v_add_u32 v7, 8, v6
  s_mul_i32 s56, s53, 54
  s_lshl_b32 s57, s54, 1
  s_add_u32 s56, s56, s57
  s_nop 4
  s_lshl_b32 s57, s52, 1
  s_add_u32 s57, s57, s56
  s_add_u32 s58, s57, 0
  s_lshl_b32 s58, s58, 12
  v_cvt_pk_bf16_f32 v16, v176, v177
  v_cvt_pk_bf16_f32 v17, v178, v179
  v_pk_max_i16 v16, v16, 0
  v_pk_max_i16 v17, v17, 0
  v_cvt_pk_bf16_f32 v18, v192, v193
  v_cvt_pk_bf16_f32 v19, v194, v195
  v_pk_max_i16 v18, v18, 0
  v_pk_max_i16 v19, v19, 0
  buffer_store_dwordx4 v[16:19], v6, s[32:35], s58 offen offset:0 sc1
  v_cvt_pk_bf16_f32 v20, v180, v181
  v_cvt_pk_bf16_f32 v21, v182, v183
  v_pk_max_i16 v20, v20, 0
  v_pk_max_i16 v21, v21, 0
  v_cvt_pk_bf16_f32 v22, v196, v197
  v_cvt_pk_bf16_f32 v23, v198, v199
  v_pk_max_i16 v22, v22, 0
  v_pk_max_i16 v23, v23, 0
  buffer_store_dwordx4 v[20:23], v6, s[32:35], s58 offen offset:1024 sc1
  v_cvt_pk_bf16_f32 v24, v184, v185
  v_cvt_pk_bf16_f32 v25, v186, v187
  v_pk_max_i16 v24, v24, 0
  v_pk_max_i16 v25, v25, 0
  v_cvt_pk_bf16_f32 v26, v200, v201
  v_cvt_pk_bf16_f32 v27, v202, v203
  v_pk_max_i16 v26, v26, 0
  v_pk_max_i16 v27, v27, 0
  buffer_store_dwordx4 v[24:27], v6, s[32:35], s58 offen offset:2048 sc1
  v_cvt_pk_bf16_f32 v28, v188, v189
  v_cvt_pk_bf16_f32 v29, v190, v191
  v_pk_max_i16 v28, v28, 0
  v_pk_max_i16 v29, v29, 0
  v_cvt_pk_bf16_f32 v30, v204, v205
  v_cvt_pk_bf16_f32 v31, v206, v207
  v_pk_max_i16 v30, v30, 0
  v_pk_max_i16 v31, v31, 0
  buffer_store_dwordx4 v[28:31], v6, s[32:35], s58 offen offset:3072 sc1
  s_add_u32 s58, s57, 1
  s_lshl_b32 s58, s58, 12
  v_cvt_pk_bf16_f32 v32, v208, v209
  v_cvt_pk_bf16_f32 v33, v210, v211
  v_pk_max_i16 v32, v32, 0
  v_pk_max_i16 v33, v33, 0
  v_cvt_pk_bf16_f32 v34, v224, v225
  v_cvt_pk_bf16_f32 v35, v226, v227
  v_pk_max_i16 v34, v34, 0
  v_pk_max_i16 v35, v35, 0
  buffer_store_dwordx4 v[32:35], v6, s[32:35], s58 offen offset:0 sc1
  v_cvt_pk_bf16_f32 v36, v212, v213
  v_cvt_pk_bf16_f32 v37, v214, v215
  v_pk_max_i16 v36, v36, 0
  v_pk_max_i16 v37, v37, 0
  v_cvt_pk_bf16_f32 v38, v228, v229
  v_cvt_pk_bf16_f32 v39, v230, v231
  v_pk_max_i16 v38, v38, 0
  v_pk_max_i16 v39, v39, 0
  buffer_store_dwordx4 v[36:39], v6, s[32:35], s58 offen offset:1024 sc1
  v_cvt_pk_bf16_f32 v40, v216, v217
  v_cvt_pk_bf16_f32 v41, v218, v219
  v_pk_max_i16 v40, v40, 0
  v_pk_max_i16 v41, v41, 0
  v_cvt_pk_bf16_f32 v42, v232, v233
  v_cvt_pk_bf16_f32 v43, v234, v235
  v_pk_max_i16 v42, v42, 0
  v_pk_max_i16 v43, v43, 0
  buffer_store_dwordx4 v[40:43], v6, s[32:35], s58 offen offset:2048 sc1
  v_cvt_pk_bf16_f32 v44, v220, v221
  v_cvt_pk_bf16_f32 v45, v222, v223
  v_pk_max_i16 v44, v44, 0
  v_pk_max_i16 v45, v45, 0
  v_cvt_pk_bf16_f32 v46, v236, v237
  v_cvt_pk_bf16_f32 v47, v238, v239
  v_pk_max_i16 v46, v46, 0
  v_pk_max_i16 v47, v47, 0
  buffer_store_dwordx4 v[44:47], v6, s[32:35], s58 offen offset:3072 sc1
  s_branch L_h_done
L_F_cons:
  s_add_u32 s32, s20, 12582912
  s_addc_u32 s33, s21, 0
  s_mov_b32 s34, 2621440
  s_mov_b32 s35, 0x00020000
  s_cmp_eq_u32 s55, 0
  s_cselect_b32 s66, 1.0, -1.0
  s_and_b32 s56, s52, 1
  s_lshr_b32 s57, s52, 1
  v_add_u32 v7, 0, v5
  v_lshrrev_b32 v8, 1, v4
  v_xor_b32 v7, v7, v8
  v_lshlrev_b32 v7, 4, v7
  v_mul_u32_u24 v8, 640, v4
  s_mul_i32 s58, s56, 20480
  v_add3_u32 v160, v7, v8, s58
  v_lshlrev_b32 v8, 7, v4
  s_mul_i32 s58, s57, 20480
  s_add_u32 s58, s58, 40960
  v_add3_u32 v162, v7, v8, s58
  v_add_u32 v7, 4, v5
  v_lshrrev_b32 v8, 1, v4
  v_xor_b32 v7, v7, v8
  v_lshlrev_b32 v7, 4, v7
  v_mul_u32_u24 v8, 640, v4
  s_mul_i32 s58, s56, 20480
  v_add3_u32 v161, v7, v8, s58
  v_lshlrev_b32 v8, 7, v4
  s_mul_i32 s58, s57, 20480
  s_add_u32 s58, s58, 40960
  v_add3_u32 v163, v7, v8, s58
  s_mul_i32 s58, s56, 20480
  s_mul_i32 s59, s57, 320
  s_add_u32 s58, s58, s59
  s_add_u32 s58, s58, 122880
  v_mul_u32_u24 v7, 2560, v5
  v_lshl_add_u32 v7, v4, 2, v7
  v_add_u32 v164, s58, v7
  v_add_u32 v165, 81920, v162
  v_add_u32 v166, 81920, v163
  v_lshlrev_b32 v9, 2, v5
  v_add_u32 v10, 0, v4
  v_add_u32 v96, 0, v9
  v_add_u32 v97, 1, v9
  v_add_u32 v98, 2, v9
  v_add_u32 v99, 3, v9
  v_add_u32 v100, 16, v9
  v_add_u32 v101, 17, v9
  v_add_u32 v102, 18, v9
  v_add_u32 v103, 19, v9
  v_mul_u32_u24 v96, v96, v10
  v_mul_u32_u24 v97, v97, v10
  v_mul_u32_u24 v98, v98, v10
  v_mul_u32_u24 v99, v99, v10
  v_mul_u32_u24 v100, v100, v10
  v_mul_u32_u24 v101, v101, v10
  v_mul_u32_u24 v102, v102, v10
  v_mul_u32_u24 v103, v103, v10
  v_and_b32 v96, 31, v96
  v_and_b32 v97, 31, v97
  v_and_b32 v98, 31, v98
  v_and_b32 v99, 31, v99
  v_and_b32 v100, 31, v100
  v_and_b32 v101, 31, v101
  v_and_b32 v102, 31, v102
  v_and_b32 v103, 31, v103
  v_cvt_f32_u32 v96, v96
  v_cvt_f32_u32 v97, v97
  v_cvt_f32_u32 v98, v98
  v_cvt_f32_u32 v99, v99
  v_cvt_f32_u32 v100, v100
  v_cvt_f32_u32 v101, v101
  v_cvt_f32_u32 v102, v102
  v_cvt_f32_u32 v103, v103
  v_mul_f32 v96, 0x3d000000, v96
  v_mul_f32 v97, 0x3d000000, v97
  v_mul_f32 v98, 0x3d000000, v98
  v_mul_f32 v99, 0x3d000000, v99
  v_mul_f32 v100, 0x3d000000, v100
  v_mul_f32 v101, 0x3d000000, v101
  v_mul_f32 v102, 0x3d000000, v102
  v_mul_f32 v103, 0x3d000000, v103
  v_sin_f32 v104, v96
  v_sin_f32 v105, v97
  v_sin_f32 v106, v98
  v_sin_f32 v107, v99
  v_sin_f32 v108, v100
  v_sin_f32 v109, v101
  v_sin_f32 v110, v102
  v_sin_f32 v111, v103
  v_cos_f32 v96, v96
  v_cos_f32 v97, v97
  v_cos_f32 v98, v98
  v_cos_f32 v99, v99
  v_cos_f32 v100, v100
  v_cos_f32 v101, v101
  v_cos_f32 v102, v102
  v_cos_f32 v103, v103
  v_cvt_pk_bf16_f32 v152, v104, v105
  v_cvt_pk_bf16_f32 v153, v106, v107
  v_cvt_pk_bf16_f32 v154, v108, v109
  v_cvt_pk_bf16_f32 v155, v110, v111
  v_cvt_pk_bf16_f32 v136, v96, v97
  v_cvt_pk_bf16_f32 v137, v98, v99
  v_cvt_pk_bf16_f32 v138, v100, v101
  v_cvt_pk_bf16_f32 v139, v102, v103
  v_xor_b32 v144, 0x80008000, v152
  v_xor_b32 v145, 0x80008000, v153
  v_xor_b32 v146, 0x80008000, v154
  v_xor_b32 v147, 0x80008000, v155
  v_add_u32 v10, 16, v4
  v_add_u32 v96, 0, v9
  v_add_u32 v97, 1, v9
  v_add_u32 v98, 2, v9
  v_add_u32 v99, 3, v9
  v_add_u32 v100, 16, v9
  v_add_u32 v101, 17, v9
  v_add_u32 v102, 18, v9
  v_add_u32 v103, 19, v9
  v_mul_u32_u24 v96, v96, v10
  v_mul_u32_u24 v97, v97, v10
  v_mul_u32_u24 v98, v98, v10
  v_mul_u32_u24 v99, v99, v10
  v_mul_u32_u24 v100, v100, v10
  v_mul_u32_u24 v101, v101, v10
  v_mul_u32_u24 v102, v102, v10
  v_mul_u32_u24 v103, v103, v10
  v_and_b32 v96, 31, v96
  v_and_b32 v97, 31, v97
  v_and_b32 v98, 31, v98
  v_and_b32 v99, 31, v99
  v_and_b32 v100, 31, v100
  v_and_b32 v101, 31, v101
  v_and_b32 v102, 31, v102
  v_and_b32 v103, 31, v103
  v_cvt_f32_u32 v96, v96
  v_cvt_f32_u32 v97, v97
  v_cvt_f32_u32 v98, v98
  v_cvt_f32_u32 v99, v99
  v_cvt_f32_u32 v100, v100
  v_cvt_f32_u32 v101, v101
  v_cvt_f32_u32 v102, v102
  v_cvt_f32_u32 v103, v103
  v_mul_f32 v96, 0x3d000000, v96
  v_mul_f32 v97, 0x3d000000, v97
  v_mul_f32 v98, 0x3d000000, v98
  v_mul_f32 v99, 0x3d000000, v99
  v_mul_f32 v100, 0x3d000000, v100
  v_mul_f32 v101, 0x3d000000, v101
  v_mul_f32 v102, 0x3d000000, v102
  v_mul_f32 v103, 0x3d000000, v103
  v_sin_f32 v104, v96
  v_sin_f32 v105, v97
  v_sin_f32 v106, v98
  v_sin_f32 v107, v99
  v_sin_f32 v108, v100
  v_sin_f32 v109, v101
  v_sin_f32 v110, v102
  v_sin_f32 v111, v103
  v_cos_f32 v96, v96
  v_cos_f32 v97, v97
  v_cos_f32 v98, v98
  v_cos_f32 v99, v99
  v_cos_f32 v100, v100
  v_cos_f32 v101, v101
  v_cos_f32 v102, v102
  v_cos_f32 v103, v103
  v_cvt_pk_bf16_f32 v156, v104, v105
  v_cvt_pk_bf16_f32 v157, v106, v107
  v_cvt_pk_bf16_f32 v158, v108, v109
  v_cvt_pk_bf16_f32 v159, v110, v111
  v_cvt_pk_bf16_f32 v140, v96, v97
  v_cvt_pk_bf16_f32 v141, v98, v99
  v_cvt_pk_bf16_f32 v142, v100, v101
  v_cvt_pk_bf16_f32 v143, v102, v103
  v_xor_b32 v148, 0x80008000, v156
  v_xor_b32 v149, 0x80008000, v157
  v_xor_b32 v150, 0x80008000, v158
  v_xor_b32 v151, 0x80008000, v159
  s_waitcnt vmcnt(10)
  v_dot2_f32_bf16 v112, v16, s69, 0
  v_dot2_f32_bf16 v116, v16, v16, 0
  v_dot2_f32_bf16 v113, v17, s69, 0
  v_dot2_f32_bf16 v117, v17, v17, 0
  v_dot2_f32_bf16 v112, v18, s69, v112
  v_dot2_f32_bf16 v116, v18, v18, v116
  v_dot2_f32_bf16 v113, v19, s69, v113
  v_dot2_f32_bf16 v117, v19, v19, v117
  v_dot2_f32_bf16 v112, v20, s69, v112
  v_dot2_f32_bf16 v116, v20, v20, v116
  v_dot2_f32_bf16 v113, v21, s69, v113
  v_dot2_f32_bf16 v117, v21, v21, v117
  v_dot2_f32_bf16 v112, v22, s69, v112
  v_dot2_f32_bf16 v116, v22, v22, v116
  v_dot2_f32_bf16 v113, v23, s69, v113
  v_dot2_f32_bf16 v117, v23, v23, v117
  v_dot2_f32_bf16 v112, v24, s69, v112
  v_dot2_f32_bf16 v116, v24, v24, v116
  v_dot2_f32_bf16 v113, v25, s69, v113
  v_dot2_f32_bf16 v117, v25, v25, v117
  v_dot2_f32_bf16 v112, v26, s69, v112
  v_dot2_f32_bf16 v116, v26, v26, v116
  v_dot2_f32_bf16 v113, v27, s69, v113
  v_dot2_f32_bf16 v117, v27, v27, v117
  v_dot2_f32_bf16 v112, v28, s69, v112
  v_dot2_f32_bf16 v116, v28, v28, v116
  v_dot2_f32_bf16 v113, v29, s69, v113
  v_dot2_f32_bf16 v117, v29, v29, v117
  v_dot2_f32_bf16 v112, v30, s69, v112
  v_dot2_f32_bf16 v116, v30, v30, v116
  v_dot2_f32_bf16 v113, v31, s69, v113
  v_dot2_f32_bf16 v117, v31, v31, v117
  v_dot2_f32_bf16 v112, v32, s69, v112
  v_dot2_f32_bf16 v116, v32, v32, v116
  v_dot2_f32_bf16 v113, v33, s69, v113
  v_dot2_f32_bf16 v117, v33, v33, v117
  v_dot2_f32_bf16 v112, v34, s69, v112
  v_dot2_f32_bf16 v116, v34, v34, v116
  v_dot2_f32_bf16 v113, v35, s69, v113
  v_dot2_f32_bf16 v117, v35, v35, v117
  v_dot2_f32_bf16 v112, v36, s69, v112
  v_dot2_f32_bf16 v116, v36, v36, v116
  v_dot2_f32_bf16 v113, v37, s69, v113
  v_dot2_f32_bf16 v117, v37, v37, v117
  v_dot2_f32_bf16 v112, v38, s69, v112
  v_dot2_f32_bf16 v116, v38, v38, v116
  v_dot2_f32_bf16 v113, v39, s69, v113
  v_dot2_f32_bf16 v117, v39, v39, v117
  v_dot2_f32_bf16 v112, v40, s69, v112
  v_dot2_f32_bf16 v116, v40, v40, v116
  v_dot2_f32_bf16 v113, v41, s69, v113
  v_dot2_f32_bf16 v117, v41, v41, v117
  v_dot2_f32_bf16 v112, v42, s69, v112
  v_dot2_f32_bf16 v116, v42, v42, v116
  v_dot2_f32_bf16 v113, v43, s69, v113
  v_dot2_f32_bf16 v117, v43, v43, v117
  v_dot2_f32_bf16 v112, v44, s69, v112
  v_dot2_f32_bf16 v116, v44, v44, v116
  v_dot2_f32_bf16 v113, v45, s69, v113
  v_dot2_f32_bf16 v117, v45, v45, v117
  v_dot2_f32_bf16 v112, v46, s69, v112
  v_dot2_f32_bf16 v116, v46, v46, v116
  v_dot2_f32_bf16 v113, v47, s69, v113
  v_dot2_f32_bf16 v117, v47, v47, v117
  v_dot2_f32_bf16 v112, v48, s69, v112
  v_dot2_f32_bf16 v116, v48, v48, v116
  v_dot2_f32_bf16 v113, v49, s69, v113
  v_dot2_f32_bf16 v117, v49, v49, v117
  v_dot2_f32_bf16 v112, v50, s69, v112
  v_dot2_f32_bf16 v116, v50, v50, v116
  v_dot2_f32_bf16 v113, v51, s69, v113
  v_dot2_f32_bf16 v117, v51, v51, v117
  v_dot2_f32_bf16 v112, v52, s69, v112
  v_dot2_f32_bf16 v116, v52, v52, v116
  v_dot2_f32_bf16 v113, v53, s69, v113
  v_dot2_f32_bf16 v117, v53, v53, v117
  v_dot2_f32_bf16 v112, v54, s69, v112
  v_dot2_f32_bf16 v116, v54, v54, v116
  v_dot2_f32_bf16 v113, v55, s69, v113
  v_dot2_f32_bf16 v117, v55, v55, v117
  s_nop 2
  v_add_f32 v112, v112, v113
  v_add_f32 v116, v116, v117
  s_nop 0
  v_add_f32_dpp v112, v112, v112 quad_perm:[1,0,3,2] row_mask:0xf bank_mask:0xf
  v_add_f32_dpp v116, v116, v116 quad_perm:[1,0,3,2] row_mask:0xf bank_mask:0xf
  s_nop 0
  v_add_f32_dpp v112, v112, v112 quad_perm:[2,3,0,1] row_mask:0xf bank_mask:0xf
  v_add_f32_dpp v116, v116, v116 quad_perm:[2,3,0,1] row_mask:0xf bank_mask:0xf
  s_nop 0
  v_add_f32_dpp v112, v112, v112 row_half_mirror row_mask:0xf bank_mask:0xf
  v_add_f32_dpp v116, v116, v116 row_half_mirror row_mask:0xf bank_mask:0xf
  s_nop 0
  v_mul_f32 v120, s67, v112
  v_mul_f32 v116, s67, v116
  v_fma_f32 v116, -v120, v120, v116
  v_max_f32 v116, 0, v116
  v_cvt_pk_bf16_f32 v120, v120, v120
  v_cvt_pk_bf16_f32 v116, v116, v116
  v_and_b32 v120, 0xffff0000, v120
  v_and_b32 v116, 0xffff0000, v116
  v_add_f32 v116, s68, v116
  v_cvt_pk_bf16_f32 v116, v116, v116
  v_and_b32 v116, 0xffff0000, v116
  v_sqrt_f32 v116, v116
  s_nop 0
  v_cvt_pk_bf16_f32 v116, v116, v116
  v_and_b32 v116, 0xffff0000, v116
  v_rcp_f32 v122, v116
  s_nop 0
  v_mul_f32 v124, v120, v122
  v_sub_f32 v124, 0, v124
  v_mov_b32 v126, s66
  v_add_f32 v7, 1.0, v126
  v_mul_f32 v124, v124, v7
  v_add_u32 v6, 0, v128
  v_bfe_u32 v7, v6, 1, 3
  v_xor_b32 v7, v7, v3
  v_mul_u32_u24 v8, 640, v6
  v_lshl_add_u32 v14, v7, 4, v8
  v_lshlrev_b32 v96, 16, v16
  v_and_b32 v97, 0xffff0000, v16
  v_lshlrev_b32 v104, 16, v36
  v_and_b32 v105, 0xffff0000, v36
  v_lshlrev_b32 v98, 16, v17
  v_and_b32 v99, 0xffff0000, v17
  v_lshlrev_b32 v106, 16, v37
  v_and_b32 v107, 0xffff0000, v37
  v_lshlrev_b32 v100, 16, v18
  v_and_b32 v101, 0xffff0000, v18
  v_lshlrev_b32 v108, 16, v38
  v_and_b32 v109, 0xffff0000, v38
  v_lshlrev_b32 v102, 16, v19
  v_and_b32 v103, 0xffff0000, v19
  v_lshlrev_b32 v110, 16, v39
  v_and_b32 v111, 0xffff0000, v39
  v_pk_fma_f32 v[96:97], v[104:105], v[126:127], v[96:97] op_sel_hi:[1,0,1]
  v_pk_fma_f32 v[98:99], v[106:107], v[126:127], v[98:99] op_sel_hi:[1,0,1]
  v_pk_fma_f32 v[100:101], v[108:109], v[126:127], v[100:101] op_sel_hi:[1,0,1]
  v_pk_fma_f32 v[102:103], v[110:111], v[126:127], v[102:103] op_sel_hi:[1,0,1]
  v_pk_fma_f32 v[96:97], v[96:97], v[122:123], v[124:125] op_sel_hi:[1,0,0]
  v_pk_fma_f32 v[98:99], v[98:99], v[122:123], v[124:125] op_sel_hi:[1,0,0]
  v_pk_fma_f32 v[100:101], v[100:101], v[122:123], v[124:125] op_sel_hi:[1,0,0]
  v_pk_fma_f32 v[102:103], v[102:103], v[122:123], v[124:125] op_sel_hi:[1,0,0]
  v_cvt_pk_bf16_f32 v16, v96, v97
  v_cvt_pk_bf16_f32 v17, v98, v99
  v_cvt_pk_bf16_f32 v18, v100, v101
  v_cvt_pk_bf16_f32 v19, v102, v103
  ds_write_b128 v14, v[16:19] offset:0
  v_lshlrev_b32 v96, 16, v20
  v_and_b32 v97, 0xffff0000, v20
  v_lshlrev_b32 v104, 16, v40
  v_and_b32 v105, 0xffff0000, v40
  v_lshlrev_b32 v98, 16, v21
  v_and_b32 v99, 0xffff0000, v21
  v_lshlrev_b32 v106, 16, v41
  v_and_b32 v107, 0xffff0000, v41
  v_lshlrev_b32 v100, 16, v22
  v_and_b32 v101, 0xffff0000, v22
  v_lshlrev_b32 v108, 16, v42
  v_and_b32 v109, 0xffff0000, v42
  v_lshlrev_b32 v102, 16, v23
  v_and_b32 v103, 0xffff0000, v23
  v_lshlrev_b32 v110, 16, v43
  v_and_b32 v111, 0xffff0000, v43
  v_pk_fma_f32 v[96:97], v[104:105], v[126:127], v[96:97] op_sel_hi:[1,0,1]
  v_pk_fma_f32 v[98:99], v[106:107], v[126:127], v[98:99] op_sel_hi:[1,0,1]
  v_pk_fma_f32 v[100:101], v[108:109], v[126:127], v[100:101] op_sel_hi:[1,0,1]
  v_pk_fma_f32 v[102:103], v[110:111], v[126:127], v[102:103] op_sel_hi:[1,0,1]
  v_pk_fma_f32 v[96:97], v[96:97], v[122:123], v[124:125] op_sel_hi:[1,0,0]
  v_pk_fma_f32 v[98:99], v[98:99], v[122:123], v[124:125] op_sel_hi:[1,0,0]
  v_pk_fma_f32 v[100:101], v[100:101], v[122:123], v[124:125] op_sel_hi:[1,0,0]
  v_pk_fma_f32 v[102:103], v[102:103], v[122:123], v[124:125] op_sel_hi:[1,0,0]
  v_cvt_pk_bf16_f32 v20, v96, v97
  v_cvt_pk_bf16_f32 v21, v98, v99
  v_cvt_pk_bf16_f32 v22, v100, v101
  v_cvt_pk_bf16_f32 v23, v102, v103
  ds_write_b128 v14, v[20:23] offset:128
  v_lshlrev_b32 v96, 16, v24
  v_and_b32 v97, 0xffff0000, v24
  v_lshlrev_b32 v104, 16, v44
  v_and_b32 v105, 0xffff0000, v44
  v_lshlrev_b32 v98, 16, v25
  v_and_b32 v99, 0xffff0000, v25
  v_lshlrev_b32 v106, 16, v45
  v_and_b32 v107, 0xffff0000, v45
  v_lshlrev_b32 v100, 16, v26
  v_and_b32 v101, 0xffff0000, v26
  v_lshlrev_b32 v108, 16, v46
  v_and_b32 v109, 0xffff0000, v46
  v_lshlrev_b32 v102, 16, v27
  v_and_b32 v103, 0xffff0000, v27
  v_lshlrev_b32 v110, 16, v47
  v_and_b32 v111, 0xffff0000, v47
  v_pk_fma_f32 v[96:97], v[104:105], v[126:127], v[96:97] op_sel_hi:[1,0,1]
  v_pk_fma_f32 v[98:99], v[106:107], v[126:127], v[98:99] op_sel_hi:[1,0,1]
  v_pk_fma_f32 v[100:101], v[108:109], v[126:127], v[100:101] op_sel_hi:[1,0,1]
  v_pk_fma_f32 v[102:103], v[110:111], v[126:127], v[102:103] op_sel_hi:[1,0,1]
  v_pk_fma_f32 v[96:97], v[96:97], v[122:123], v[124:125] op_sel_hi:[1,0,0]
  v_pk_fma_f32 v[98:99], v[98:99], v[122:123], v[124:125] op_sel_hi:[1,0,0]
  v_pk_fma_f32 v[100:101], v[100:101], v[122:123], v[124:125] op_sel_hi:[1,0,0]
  v_pk_fma_f32 v[102:103], v[102:103], v[122:123], v[124:125] op_sel_hi:[1,0,0]
  v_cvt_pk_bf16_f32 v24, v96, v97
  v_cvt_pk_bf16_f32 v25, v98, v99
  v_cvt_pk_bf16_f32 v26, v100, v101
  v_cvt_pk_bf16_f32 v27, v102, v103
  ds_write_b128 v14, v[24:27] offset:256
  v_lshlrev_b32 v96, 16, v28
  v_and_b32 v97, 0xffff0000, v28
  v_lshlrev_b32 v104, 16, v48
  v_and_b32 v105, 0xffff0000, v48
  v_lshlrev_b32 v98, 16, v29
  v_and_b32 v99, 0xffff0000, v29
  v_lshlrev_b32 v106, 16, v49
  v_and_b32 v107, 0xffff0000, v49
  v_lshlrev_b32 v100, 16, v30
  v_and_b32 v101, 0xffff0000, v30
  v_lshlrev_b32 v108, 16, v50
  v_and_b32 v109, 0xffff0000, v50
  v_lshlrev_b32 v102, 16, v31
  v_and_b32 v103, 0xffff0000, v31
  v_lshlrev_b32 v110, 16, v51
  v_and_b32 v111, 0xffff0000, v51
  v_pk_fma_f32 v[96:97], v[104:105], v[126:127], v[96:97] op_sel_hi:[1,0,1]
  v_pk_fma_f32 v[98:99], v[106:107], v[126:127], v[98:99] op_sel_hi:[1,0,1]
  v_pk_fma_f32 v[100:101], v[108:109], v[126:127], v[100:101] op_sel_hi:[1,0,1]
  v_pk_fma_f32 v[102:103], v[110:111], v[126:127], v[102:103] op_sel_hi:[1,0,1]
  v_pk_fma_f32 v[96:97], v[96:97], v[122:123], v[124:125] op_sel_hi:[1,0,0]
  v_pk_fma_f32 v[98:99], v[98:99], v[122:123], v[124:125] op_sel_hi:[1,0,0]
  v_pk_fma_f32 v[100:101], v[100:101], v[122:123], v[124:125] op_sel_hi:[1,0,0]
  v_pk_fma_f32 v[102:103], v[102:103], v[122:123], v[124:125] op_sel_hi:[1,0,0]
  v_cvt_pk_bf16_f32 v28, v96, v97
  v_cvt_pk_bf16_f32 v29, v98, v99
  v_cvt_pk_bf16_f32 v30, v100, v101
  v_cvt_pk_bf16_f32 v31, v102, v103
  ds_write_b128 v14, v[28:31] offset:384
  v_lshlrev_b32 v96, 16, v32
  v_and_b32 v97, 0xffff0000, v32
  v_lshlrev_b32 v104, 16, v52
  v_and_b32 v105, 0xffff0000, v52
  v_lshlrev_b32 v98, 16, v33
  v_and_b32 v99, 0xffff0000, v33
  v_lshlrev_b32 v106, 16, v53
  v_and_b32 v107, 0xffff0000, v53
  v_lshlrev_b32 v100, 16, v34
  v_and_b32 v101, 0xffff0000, v34
  v_lshlrev_b32 v108, 16, v54
  v_and_b32 v109, 0xffff0000, v54
  v_lshlrev_b32 v102, 16, v35
  v_and_b32 v103, 0xffff0000, v35
  v_lshlrev_b32 v110, 16, v55
  v_and_b32 v111, 0xffff0000, v55
  v_pk_fma_f32 v[96:97], v[104:105], v[126:127], v[96:97] op_sel_hi:[1,0,1]
  v_pk_fma_f32 v[98:99], v[106:107], v[126:127], v[98:99] op_sel_hi:[1,0,1]
  v_pk_fma_f32 v[100:101], v[108:109], v[126:127], v[100:101] op_sel_hi:[1,0,1]
  v_pk_fma_f32 v[102:103], v[110:111], v[126:127], v[102:103] op_sel_hi:[1,0,1]
  v_pk_fma_f32 v[96:97], v[96:97], v[122:123], v[124:125] op_sel_hi:[1,0,0]
  v_pk_fma_f32 v[98:99], v[98:99], v[122:123], v[124:125] op_sel_hi:[1,0,0]
  v_pk_fma_f32 v[100:101], v[100:101], v[122:123], v[124:125] op_sel_hi:[1,0,0]
  v_pk_fma_f32 v[102:103], v[102:103], v[122:123], v[124:125] op_sel_hi:[1,0,0]
  v_cvt_pk_bf16_f32 v32, v96, v97
  v_cvt_pk_bf16_f32 v33, v98, v99
  v_cvt_pk_bf16_f32 v34, v100, v101
  v_cvt_pk_bf16_f32 v35, v102, v103
  ds_write_b128 v14, v[32:35] offset:512
  s_waitcnt vmcnt(0)
  v_dot2_f32_bf16 v112, v56, s69, 0
  v_dot2_f32_bf16 v116, v56, v56, 0
  v_dot2_f32_bf16 v113, v57, s69, 0
  v_dot2_f32_bf16 v117, v57, v57, 0
  v_dot2_f32_bf16 v112, v58, s69, v112
  v_dot2_f32_bf16 v116, v58, v58, v116
  v_dot2_f32_bf16 v113, v59, s69, v113
  v_dot2_f32_bf16 v117, v59, v59, v117
  v_dot2_f32_bf16 v112, v60, s69, v112
  v_dot2_f32_bf16 v116, v60, v60, v116
  v_dot2_f32_bf16 v113, v61, s69, v113
  v_dot2_f32_bf16 v117, v61, v61, v117
  v_dot2_f32_bf16 v112, v62, s69, v112
  v_dot2_f32_bf16 v116, v62, v62, v116
  v_dot2_f32_bf16 v113, v63, s69, v113
  v_dot2_f32_bf16 v117, v63, v63, v117
  v_dot2_f32_bf16 v112, v64, s69, v112
  v_dot2_f32_bf16 v116, v64, v64, v116
  v_dot2_f32_bf16 v113, v65, s69, v113
  v_dot2_f32_bf16 v117, v65, v65, v117
  v_dot2_f32_bf16 v112, v66, s69, v112
  v_dot2_f32_bf16 v116, v66, v66, v116
  v_dot2_f32_bf16 v113, v67, s69, v113
  v_dot2_f32_bf16 v117, v67, v67, v117
  v_dot2_f32_bf16 v112, v68, s69, v112
  v_dot2_f32_bf16 v116, v68, v68, v116
  v_dot2_f32_bf16 v113, v69, s69, v113
  v_dot2_f32_bf16 v117, v69, v69, v117
  v_dot2_f32_bf16 v112, v70, s69, v112
  v_dot2_f32_bf16 v116, v70, v70, v116
  v_dot2_f32_bf16 v113, v71, s69, v113
  v_dot2_f32_bf16 v117, v71, v71, v117
  v_dot2_f32_bf16 v112, v72, s69, v112
  v_dot2_f32_bf16 v116, v72, v72, v116
  v_dot2_f32_bf16 v113, v73, s69, v113
  v_dot2_f32_bf16 v117, v73, v73, v117
  v_dot2_f32_bf16 v112, v74, s69, v112
  v_dot2_f32_bf16 v116, v74, v74, v116
  v_dot2_f32_bf16 v113, v75, s69, v113
  v_dot2_f32_bf16 v117, v75, v75, v117
  v_dot2_f32_bf16 v112, v76, s69, v112
  v_dot2_f32_bf16 v116, v76, v76, v116
  v_dot2_f32_bf16 v113, v77, s69, v113
  v_dot2_f32_bf16 v117, v77, v77, v117
  v_dot2_f32_bf16 v112, v78, s69, v112
  v_dot2_f32_bf16 v116, v78, v78, v116
  v_dot2_f32_bf16 v113, v79, s69, v113
  v_dot2_f32_bf16 v117, v79, v79, v117
  v_dot2_f32_bf16 v112, v80, s69, v112
  v_dot2_f32_bf16 v116, v80, v80, v116
  v_dot2_f32_bf16 v113, v81, s69, v113
  v_dot2_f32_bf16 v117, v81, v81, v117
  v_dot2_f32_bf16 v112, v82, s69, v112
  v_dot2_f32_bf16 v116, v82, v82, v116
  v_dot2_f32_bf16 v113, v83, s69, v113
  v_dot2_f32_bf16 v117, v83, v83, v117
  v_dot2_f32_bf16 v112, v84, s69, v112
  v_dot2_f32_bf16 v116, v84, v84, v116
  v_dot2_f32_bf16 v113, v85, s69, v113
  v_dot2_f32_bf16 v117, v85, v85, v117
  v_dot2_f32_bf16 v112, v86, s69, v112
  v_dot2_f32_bf16 v116, v86, v86, v116
  v_dot2_f32_bf16 v113, v87, s69, v113
  v_dot2_f32_bf16 v117, v87, v87, v117
  v_dot2_f32_bf16 v112, v88, s69, v112
  v_dot2_f32_bf16 v116, v88, v88, v116
  v_dot2_f32_bf16 v113, v89, s69, v113
  v_dot2_f32_bf16 v117, v89, v89, v117
  v_dot2_f32_bf16 v112, v90, s69, v112
  v_dot2_f32_bf16 v116, v90, v90, v116
  v_dot2_f32_bf16 v113, v91, s69, v113
  v_dot2_f32_bf16 v117, v91, v91, v117
  v_dot2_f32_bf16 v112, v92, s69, v112
  v_dot2_f32_bf16 v116, v92, v92, v116
  v_dot2_f32_bf16 v113, v93, s69, v113
  v_dot2_f32_bf16 v117, v93, v93, v117
  v_dot2_f32_bf16 v112, v94, s69, v112
  v_dot2_f32_bf16 v116, v94, v94, v116
  v_dot2_f32_bf16 v113, v95, s69, v113
  v_dot2_f32_bf16 v117, v95, v95, v117
  s_nop 2
  v_add_f32 v112, v112, v113
  v_add_f32 v116, v116, v117
  s_nop 0
  v_add_f32_dpp v112, v112, v112 quad_perm:[1,0,3,2] row_mask:0xf bank_mask:0xf
  v_add_f32_dpp v116, v116, v116 quad_perm:[1,0,3,2] row_mask:0xf bank_mask:0xf
  s_nop 0
  v_add_f32_dpp v112, v112, v112 quad_perm:[2,3,0,1] row_mask:0xf bank_mask:0xf
  v_add_f32_dpp v116, v116, v116 quad_perm:[2,3,0,1] row_mask:0xf bank_mask:0xf
  s_nop 0
  v_add_f32_dpp v112, v112, v112 row_half_mirror row_mask:0xf bank_mask:0xf
  v_add_f32_dpp v116, v116, v116 row_half_mirror row_mask:0xf bank_mask:0xf
  s_nop 0
  v_mul_f32 v120, s67, v112
  v_mul_f32 v116, s67, v116
  v_fma_f32 v116, -v120, v120, v116
  v_max_f32 v116, 0, v116
  v_cvt_pk_bf16_f32 v120, v120, v120
  v_cvt_pk_bf16_f32 v116, v116, v116
  v_and_b32 v120, 0xffff0000, v120
  v_and_b32 v116, 0xffff0000, v116
  v_add_f32 v116, s68, v116
  v_cvt_pk_bf16_f32 v116, v116, v116
  v_and_b32 v116, 0xffff0000, v116
  v_sqrt_f32 v116, v116
  s_nop 0
  v_cvt_pk_bf16_f32 v116, v116, v116
  v_and_b32 v116, 0xffff0000, v116
  v_rcp_f32 v122, v116
  s_nop 0
  v_mul_f32 v124, v120, v122
  v_sub_f32 v124, 0, v124
  v_mov_b32 v126, s66
  v_add_f32 v7, 1.0, v126
  v_mul_f32 v124, v124, v7
  v_add_u32 v6, 8, v128
  v_bfe_u32 v7, v6, 1, 3
  v_xor_b32 v7, v7, v3
  v_mul_u32_u24 v8, 640, v6
  v_lshl_add_u32 v14, v7, 4, v8
  v_lshlrev_b32 v96, 16, v56
  v_and_b32 v97, 0xffff0000, v56
  v_lshlrev_b32 v104, 16, v76
  v_and_b32 v105, 0xffff0000, v76
  v_lshlrev_b32 v98, 16, v57
  v_and_b32 v99, 0xffff0000, v57
  v_lshlrev_b32 v106, 16, v77
  v_and_b32 v107, 0xffff0000, v77
  v_lshlrev_b32 v100, 16, v58
  v_and_b32 v101, 0xffff0000, v58
  v_lshlrev_b32 v108, 16, v78
  v_and_b32 v109, 0xffff0000, v78
  v_lshlrev_b32 v102, 16, v59
  v_and_b32 v103, 0xffff0000, v59
  v_lshlrev_b32 v110, 16, v79
  v_and_b32 v111, 0xffff0000, v79
  v_pk_fma_f32 v[96:97], v[104:105], v[126:127], v[96:97] op_sel_hi:[1,0,1]
  v_pk_fma_f32 v[98:99], v[106:107], v[126:127], v[98:99] op_sel_hi:[1,0,1]
  v_pk_fma_f32 v[100:101], v[108:109], v[126:127], v[100:101] op_sel_hi:[1,0,1]
  v_pk_fma_f32 v[102:103], v[110:111], v[126:127], v[102:103] op_sel_hi:[1,0,1]
  v_pk_fma_f32 v[96:97], v[96:97], v[122:123], v[124:125] op_sel_hi:[1,0,0]
  v_pk_fma_f32 v[98:99], v[98:99], v[122:123], v[124:125] op_sel_hi:[1,0,0]
  v_pk_fma_f32 v[100:101], v[100:101], v[122:123], v[124:125] op_sel_hi:[1,0,0]
  v_pk_fma_f32 v[102:103], v[102:103], v[122:123], v[124:125] op_sel_hi:[1,0,0]
  v_cvt_pk_bf16_f32 v56, v96, v97
  v_cvt_pk_bf16_f32 v57, v98, v99
  v_cvt_pk_bf16_f32 v58, v100, v101
  v_cvt_pk_bf16_f32 v59, v102, v103
  ds_write_b128 v14, v[56:59] offset:0
  v_lshlrev_b32 v96, 16, v60
  v_and_b32 v97, 0xffff0000, v60
  v_lshlrev_b32 v104, 16, v80
  v_and_b32 v105, 0xffff0000, v80
  v_lshlrev_b32 v98, 16, v61
  v_and_b32 v99, 0xffff0000, v61
  v_lshlrev_b32 v106, 16, v81
  v_and_b32 v107, 0xffff0000, v81
  v_lshlrev_b32 v100, 16, v62
  v_and_b32 v101, 0xffff0000, v62
  v_lshlrev_b32 v108, 16, v82
  v_and_b32 v109, 0xffff0000, v82
  v_lshlrev_b32 v102, 16, v63
  v_and_b32 v103, 0xffff0000, v63
  v_lshlrev_b32 v110, 16, v83
  v_and_b32 v111, 0xffff0000, v83
  v_pk_fma_f32 v[96:97], v[104:105], v[126:127], v[96:97] op_sel_hi:[1,0,1]
  v_pk_fma_f32 v[98:99], v[106:107], v[126:127], v[98:99] op_sel_hi:[1,0,1]
  v_pk_fma_f32 v[100:101], v[108:109], v[126:127], v[100:101] op_sel_hi:[1,0,1]
  v_pk_fma_f32 v[102:103], v[110:111], v[126:127], v[102:103] op_sel_hi:[1,0,1]
  v_pk_fma_f32 v[96:97], v[96:97], v[122:123], v[124:125] op_sel_hi:[1,0,0]
  v_pk_fma_f32 v[98:99], v[98:99], v[122:123], v[124:125] op_sel_hi:[1,0,0]
  v_pk_fma_f32 v[100:101], v[100:101], v[122:123], v[124:125] op_sel_hi:[1,0,0]
  v_pk_fma_f32 v[102:103], v[102:103], v[122:123], v[124:125] op_sel_hi:[1,0,0]
  v_cvt_pk_bf16_f32 v60, v96, v97
  v_cvt_pk_bf16_f32 v61, v98, v99
  v_cvt_pk_bf16_f32 v62, v100, v101
  v_cvt_pk_bf16_f32 v63, v102, v103
  ds_write_b128 v14, v[60:63] offset:128
  v_lshlrev_b32 v96, 16, v64
  v_and_b32 v97, 0xffff0000, v64
  v_lshlrev_b32 v104, 16, v84
  v_and_b32 v105, 0xffff0000, v84
  v_lshlrev_b32 v98, 16, v65
  v_and_b32 v99, 0xffff0000, v65
  v_lshlrev_b32 v106, 16, v85
  v_and_b32 v107, 0xffff0000, v85
  v_lshlrev_b32 v100, 16, v66
  v_and_b32 v101, 0xffff0000, v66
  v_lshlrev_b32 v108, 16, v86
  v_and_b32 v109, 0xffff0000, v86
  v_lshlrev_b32 v102, 16, v67
  v_and_b32 v103, 0xffff0000, v67
  v_lshlrev_b32 v110, 16, v87
  v_and_b32 v111, 0xffff0000, v87
  v_pk_fma_f32 v[96:97], v[104:105], v[126:127], v[96:97] op_sel_hi:[1,0,1]
  v_pk_fma_f32 v[98:99], v[106:107], v[126:127], v[98:99] op_sel_hi:[1,0,1]
  v_pk_fma_f32 v[100:101], v[108:109], v[126:127], v[100:101] op_sel_hi:[1,0,1]
  v_pk_fma_f32 v[102:103], v[110:111], v[126:127], v[102:103] op_sel_hi:[1,0,1]
  v_pk_fma_f32 v[96:97], v[96:97], v[122:123], v[124:125] op_sel_hi:[1,0,0]
  v_pk_fma_f32 v[98:99], v[98:99], v[122:123], v[124:125] op_sel_hi:[1,0,0]
  v_pk_fma_f32 v[100:101], v[100:101], v[122:123], v[124:125] op_sel_hi:[1,0,0]
  v_pk_fma_f32 v[102:103], v[102:103], v[122:123], v[124:125] op_sel_hi:[1,0,0]
  v_cvt_pk_bf16_f32 v64, v96, v97
  v_cvt_pk_bf16_f32 v65, v98, v99
  v_cvt_pk_bf16_f32 v66, v100, v101
  v_cvt_pk_bf16_f32 v67, v102, v103
  ds_write_b128 v14, v[64:67] offset:256
  v_lshlrev_b32 v96, 16, v68
  v_and_b32 v97, 0xffff0000, v68
  v_lshlrev_b32 v104, 16, v88
  v_and_b32 v105, 0xffff0000, v88
  v_lshlrev_b32 v98, 16, v69
  v_and_b32 v99, 0xffff0000, v69
  v_lshlrev_b32 v106, 16, v89
  v_and_b32 v107, 0xffff0000, v89
  v_lshlrev_b32 v100, 16, v70
  v_and_b32 v101, 0xffff0000, v70
  v_lshlrev_b32 v108, 16, v90
  v_and_b32 v109, 0xffff0000, v90
  v_lshlrev_b32 v102, 16, v71
  v_and_b32 v103, 0xffff0000, v71
  v_lshlrev_b32 v110, 16, v91
  v_and_b32 v111, 0xffff0000, v91
  v_pk_fma_f32 v[96:97], v[104:105], v[126:127], v[96:97] op_sel_hi:[1,0,1]
  v_pk_fma_f32 v[98:99], v[106:107], v[126:127], v[98:99] op_sel_hi:[1,0,1]
  v_pk_fma_f32 v[100:101], v[108:109], v[126:127], v[100:101] op_sel_hi:[1,0,1]
  v_pk_fma_f32 v[102:103], v[110:111], v[126:127], v[102:103] op_sel_hi:[1,0,1]
  v_pk_fma_f32 v[96:97], v[96:97], v[122:123], v[124:125] op_sel_hi:[1,0,0]
  v_pk_fma_f32 v[98:99], v[98:99], v[122:123], v[124:125] op_sel_hi:[1,0,0]
  v_pk_fma_f32 v[100:101], v[100:101], v[122:123], v[124:125] op_sel_hi:[1,0,0]
  v_pk_fma_f32 v[102:103], v[102:103], v[122:123], v[124:125] op_sel_hi:[1,0,0]
  v_cvt_pk_bf16_f32 v68, v96, v97
  v_cvt_pk_bf16_f32 v69, v98, v99
  v_cvt_pk_bf16_f32 v70, v100, v101
  v_cvt_pk_bf16_f32 v71, v102, v103
  ds_write_b128 v14, v[68:71] offset:384
  v_lshlrev_b32 v96, 16, v72
  v_and_b32 v97, 0xffff0000, v72
  v_lshlrev_b32 v104, 16, v92
  v_and_b32 v105, 0xffff0000, v92
  v_lshlrev_b32 v98, 16, v73
  v_and_b32 v99, 0xffff0000, v73
  v_lshlrev_b32 v106, 16, v93
  v_and_b32 v107, 0xffff0000, v93
  v_lshlrev_b32 v100, 16, v74
  v_and_b32 v101, 0xffff0000, v74
  v_lshlrev_b32 v108, 16, v94
  v_and_b32 v109, 0xffff0000, v94
  v_lshlrev_b32 v102, 16, v75
  v_and_b32 v103, 0xffff0000, v75
  v_lshlrev_b32 v110, 16, v95
  v_and_b32 v111, 0xffff0000, v95
  v_pk_fma_f32 v[96:97], v[104:105], v[126:127], v[96:97] op_sel_hi:[1,0,1]
  v_pk_fma_f32 v[98:99], v[106:107], v[126:127], v[98:99] op_sel_hi:[1,0,1]
  v_pk_fma_f32 v[100:101], v[108:109], v[126:127], v[100:101] op_sel_hi:[1,0,1]
  v_pk_fma_f32 v[102:103], v[110:111], v[126:127], v[102:103] op_sel_hi:[1,0,1]
  v_pk_fma_f32 v[96:97], v[96:97], v[122:123], v[124:125] op_sel_hi:[1,0,0]
  v_pk_fma_f32 v[98:99], v[98:99], v[122:123], v[124:125] op_sel_hi:[1,0,0]
  v_pk_fma_f32 v[100:101], v[100:101], v[122:123], v[124:125] op_sel_hi:[1,0,0]
  v_pk_fma_f32 v[102:103], v[102:103], v[122:123], v[124:125] op_sel_hi:[1,0,0]
  v_cvt_pk_bf16_f32 v72, v96, v97
  v_cvt_pk_bf16_f32 v73, v98, v99
  v_cvt_pk_bf16_f32 v74, v100, v101
  v_cvt_pk_bf16_f32 v75, v102, v103
  ds_write_b128 v14, v[72:75] offset:512
  s_waitcnt lgkmcnt(0)
  s_barrier
  ds_read_b128 v[16:19], v160 offset:0
  ds_read_b128 v[20:23], v161 offset:0
  ds_read_b128 v[24:27], v160 offset:10240
  ds_read_b128 v[28:31], v161 offset:10240
  ds_read_b128 v[48:51], v162 offset:0
  ds_read_b128 v[52:55], v163 offset:0
  ds_read_b128 v[56:59], v162 offset:2048
  ds_read_b128 v[60:63], v163 offset:2048
  ds_read_b128 v[64:67], v162 offset:4096
  ds_read_b128 v[68:71], v163 offset:4096
  ds_read_b128 v[72:75], v162 offset:6144
  ds_read_b128 v[76:79], v163 offset:6144
  s_waitcnt lgkmcnt(4)
  v_mfma_f32_16x16x32_bf16 v[176:179], v[16:19], v[48:51], 0
  ds_read_b128 v[120:123], v162 offset:8192
  v_mfma_f32_16x16x32_bf16 v[180:183], v[24:27], v[48:51], 0
  ds_read_b128 v[124:127], v163 offset:8192
  v_mfma_f32_16x16x32_bf16 v[184:187], v[16:19], v[56:59], 0
  ds_read_b128 v[128:131], v162 offset:10240
  v_mfma_f32_16x16x32_bf16 v[188:191], v[24:27], v[56:59], 0
  ds_read_b128 v[132:135], v163 offset:10240
  v_mfma_f32_16x16x32_bf16 v[176:179], v[20:23], v[52:55], v[176:179]
  v_mfma_f32_16x16x32_bf16 v[180:183], v[28:31], v[52:55], v[180:183]
  v_mfma_f32_16x16x32_bf16 v[184:187], v[20:23], v[60:63], v[184:187]
  v_mfma_f32_16x16x32_bf16 v[188:191], v[28:31], v[60:63], v[188:191]
  s_waitcnt lgkmcnt(4)
  v_mfma_f32_16x16x32_bf16 v[192:195], v[16:19], v[64:67], 0
  ds_read_b128 v[48:51], v162 offset:12288
  v_mfma_f32_16x16x32_bf16 v[196:199], v[24:27], v[64:67], 0
  ds_read_b128 v[52:55], v163 offset:12288
  v_mfma_f32_16x16x32_bf16 v[200:203], v[16:19], v[72:75], 0
  ds_read_b128 v[56:59], v162 offset:14336
  v_mfma_f32_16x16x32_bf16 v[204:207], v[24:27], v[72:75], 0
  ds_read_b128 v[60:63], v163 offset:14336
  v_mfma_f32_16x16x32_bf16 v[192:195], v[20:23], v[68:71], v[192:195]
  v_mfma_f32_16x16x32_bf16 v[196:199], v[28:31], v[68:71], v[196:199]
  v_mfma_f32_16x16x32_bf16 v[200:203], v[20:23], v[76:79], v[200:203]
  v_mfma_f32_16x16x32_bf16 v[204:207], v[28:31], v[76:79], v[204:207]
  s_waitcnt lgkmcnt(4)
  v_mfma_f32_16x16x32_bf16 v[208:211], v[16:19], v[120:123], 0
  ds_read_b128 v[64:67], v162 offset:16384
  v_mfma_f32_16x16x32_bf16 v[212:215], v[24:27], v[120:123], 0
  ds_read_b128 v[68:71], v163 offset:16384
  v_mfma_f32_16x16x32_bf16 v[216:219], v[16:19], v[128:131], 0
  ds_read_b128 v[72:75], v162 offset:18432
  v_mfma_f32_16x16x32_bf16 v[220:223], v[24:27], v[128:131], 0
  ds_read_b128 v[76:79], v163 offset:18432
  v_mfma_f32_16x16x32_bf16 v[208:211], v[20:23], v[124:127], v[208:211]
  v_mfma_f32_16x16x32_bf16 v[212:215], v[28:31], v[124:127], v[212:215]
  v_mfma_f32_16x16x32_bf16 v[216:219], v[20:23], v[132:135], v[216:219]
  v_mfma_f32_16x16x32_bf16 v[220:223], v[28:31], v[132:135], v[220:223]
  s_waitcnt lgkmcnt(4)
  v_mfma_f32_16x16x32_bf16 v[224:227], v[16:19], v[48:51], 0
  v_mfma_f32_16x16x32_bf16 v[228:231], v[24:27], v[48:51], 0
  v_mfma_f32_16x16x32_bf16 v[232:235], v[16:19], v[56:59], 0
  v_mfma_f32_16x16x32_bf16 v[236:239], v[24:27], v[56:59], 0
  v_mfma_f32_16x16x32_bf16 v[224:227], v[20:23], v[52:55], v[224:227]
  v_mfma_f32_16x16x32_bf16 v[228:231], v[28:31], v[52:55], v[228:231]
  v_mfma_f32_16x16x32_bf16 v[232:235], v[20:23], v[60:63], v[232:235]
  v_mfma_f32_16x16x32_bf16 v[236:239], v[28:31], v[60:63], v[236:239]
  s_waitcnt lgkmcnt(0)
  s_barrier
  v_mfma_f32_16x16x32_bf16 v[240:243], v[16:19], v[64:67], 0
  ds_read_b128 v[32:35], v160 offset:128
  ds_read_b128 v[36:39], v161 offset:128
  v_mfma_f32_16x16x32_bf16 v[244:247], v[24:27], v[64:67], 0
  ds_read_b128 v[40:43], v160 offset:10368
  ds_read_b128 v[44:47], v161 offset:10368
  v_mfma_f32_16x16x32_bf16 v[248:251], v[16:19], v[72:75], 0
  ds_read_b128 v[120:123], v162 offset:40960
  ds_read_b128 v[124:127], v163 offset:40960
  v_mfma_f32_16x16x32_bf16 v[252:255], v[24:27], v[72:75], 0
  ds_read_b128 v[128:131], v162 offset:43008
  ds_read_b128 v[132:135], v163 offset:43008
  v_mfma_f32_16x16x32_bf16 v[240:243], v[20:23], v[68:71], v[240:243]
  ds_read_b128 v[48:51], v162 offset:45056
  ds_read_b128 v[52:55], v163 offset:45056
  v_mfma_f32_16x16x32_bf16 v[244:247], v[28:31], v[68:71], v[244:247]
  ds_read_b128 v[56:59], v162 offset:47104
  ds_read_b128 v[60:63], v163 offset:47104
  v_mfma_f32_16x16x32_bf16 v[248:251], v[20:23], v[76:79], v[248:251]
  v_mfma_f32_16x16x32_bf16 v[252:255], v[28:31], v[76:79], v[252:255]
  s_waitcnt lgkmcnt(4)
  v_mfma_f32_16x16x32_bf16 v[176:179], v[32:35], v[120:123], v[176:179]
  ds_read_b128 v[64:67], v162 offset:49152
  v_mfma_f32_16x16x32_bf16 v[180:183], v[40:43], v[120:123], v[180:183]
  ds_read_b128 v[68:71], v163 offset:49152
  v_mfma_f32_16x16x32_bf16 v[184:187], v[32:35], v[128:131], v[184:187]
  ds_read_b128 v[72:75], v162 offset:51200
  v_mfma_f32_16x16x32_bf16 v[188:191], v[40:43], v[128:131], v[188:191]
  ds_read_b128 v[76:79], v163 offset:51200
  v_mfma_f32_16x16x32_bf16 v[176:179], v[36:39], v[124:127], v[176:179]
  v_mfma_f32_16x16x32_bf16 v[180:183], v[44:47], v[124:127], v[180:183]
  v_mfma_f32_16x16x32_bf16 v[184:187], v[36:39], v[132:135], v[184:187]
  v_mfma_f32_16x16x32_bf16 v[188:191], v[44:47], v[132:135], v[188:191]
  s_waitcnt lgkmcnt(4)
  v_mfma_f32_16x16x32_bf16 v[192:195], v[32:35], v[48:51], v[192:195]
  ds_read_b128 v[120:123], v162 offset:53248
  v_mfma_f32_16x16x32_bf16 v[196:199], v[40:43], v[48:51], v[196:199]
  ds_read_b128 v[124:127], v163 offset:53248
  v_mfma_f32_16x16x32_bf16 v[200:203], v[32:35], v[56:59], v[200:203]
  ds_read_b128 v[128:131], v162 offset:55296
  v_mfma_f32_16x16x32_bf16 v[204:207], v[40:43], v[56:59], v[204:207]
  ds_read_b128 v[132:135], v163 offset:55296
  v_mfma_f32_16x16x32_bf16 v[192:195], v[36:39], v[52:55], v[192:195]
  v_mfma_f32_16x16x32_bf16 v[196:199], v[44:47], v[52:55], v[196:199]
  v_mfma_f32_16x16x32_bf16 v[200:203], v[36:39], v[60:63], v[200:203]
  v_mfma_f32_16x16x32_bf16 v[204:207], v[44:47], v[60:63], v[204:207]
  s_waitcnt lgkmcnt(4)
  v_mfma_f32_16x16x32_bf16 v[208:211], v[32:35], v[64:67], v[208:211]
  ds_read_b128 v[48:51], v162 offset:57344
  v_mfma_f32_16x16x32_bf16 v[212:215], v[40:43], v[64:67], v[212:215]
  ds_read_b128 v[52:55], v163 offset:57344
  v_mfma_f32_16x16x32_bf16 v[216:219], v[32:35], v[72:75], v[216:219]
  ds_read_b128 v[56:59], v162 offset:59392
  v_mfma_f32_16x16x32_bf16 v[220:223], v[40:43], v[72:75], v[220:223]
  ds_read_b128 v[60:63], v163 offset:59392
  v_mfma_f32_16x16x32_bf16 v[208:211], v[36:39], v[68:71], v[208:211]
  v_mfma_f32_16x16x32_bf16 v[212:215], v[44:47], v[68:71], v[212:215]
  v_mfma_f32_16x16x32_bf16 v[216:219], v[36:39], v[76:79], v[216:219]
  v_mfma_f32_16x16x32_bf16 v[220:223], v[44:47], v[76:79], v[220:223]
  s_waitcnt lgkmcnt(4)
  v_mfma_f32_16x16x32_bf16 v[224:227], v[32:35], v[120:123], v[224:227]
  v_mfma_f32_16x16x32_bf16 v[228:231], v[40:43], v[120:123], v[228:231]
  v_mfma_f32_16x16x32_bf16 v[232:235], v[32:35], v[128:131], v[232:235]
  v_mfma_f32_16x16x32_bf16 v[236:239], v[40:43], v[128:131], v[236:239]
  v_mfma_f32_16x16x32_bf16 v[224:227], v[36:39], v[124:127], v[224:227]
  v_mfma_f32_16x16x32_bf16 v[228:231], v[44:47], v[124:127], v[228:231]
  v_mfma_f32_16x16x32_bf16 v[232:235], v[36:39], v[132:135], v[232:235]
  v_mfma_f32_16x16x32_bf16 v[236:239], v[44:47], v[132:135], v[236:239]
  s_waitcnt lgkmcnt(0)
  s_barrier
  v_mfma_f32_16x16x32_bf16 v[240:243], v[32:35], v[48:51], v[240:243]
  ds_read_b128 v[16:19], v160 offset:256
  ds_read_b128 v[20:23], v161 offset:256
  v_mfma_f32_16x16x32_bf16 v[244:247], v[40:43], v[48:51], v[244:247]
  ds_read_b128 v[24:27], v160 offset:10496
  ds_read_b128 v[28:31], v161 offset:10496
  v_mfma_f32_16x16x32_bf16 v[248:251], v[32:35], v[56:59], v[248:251]
  ds_read_b128 v[64:67], v165 offset:0
  ds_read_b128 v[68:71], v166 offset:0
  v_mfma_f32_16x16x32_bf16 v[252:255], v[40:43], v[56:59], v[252:255]
  ds_read_b128 v[72:75], v165 offset:2048
  ds_read_b128 v[76:79], v166 offset:2048
  v_mfma_f32_16x16x32_bf16 v[240:243], v[36:39], v[52:55], v[240:243]
  ds_read_b128 v[120:123], v165 offset:4096
  ds_read_b128 v[124:127], v166 offset:4096
  v_mfma_f32_16x16x32_bf16 v[244:247], v[44:47], v[52:55], v[244:247]
  ds_read_b128 v[128:131], v165 offset:6144
  ds_read_b128 v[132:135], v166 offset:6144
  v_mfma_f32_16x16x32_bf16 v[248:251], v[36:39], v[60:63], v[248:251]
  v_mfma_f32_16x16x32_bf16 v[252:255], v[44:47], v[60:63], v[252:255]
  s_waitcnt lgkmcnt(4)
  v_mfma_f32_16x16x32_bf16 v[176:179], v[16:19], v[64:67], v[176:179]
  ds_read_b128 v[48:51], v165 offset:8192
  v_mfma_f32_16x16x32_bf16 v[180:183], v[24:27], v[64:67], v[180:183]
  ds_read_b128 v[52:55], v166 offset:8192
  v_mfma_f32_16x16x32_bf16 v[184:187], v[16:19], v[72:75], v[184:187]
  ds_read_b128 v[56:59], v165 offset:10240
  v_mfma_f32_16x16x32_bf16 v[188:191], v[24:27], v[72:75], v[188:191]
  ds_read_b128 v[60:63], v166 offset:10240
  v_mfma_f32_16x16x32_bf16 v[176:179], v[20:23], v[68:71], v[176:179]
  v_mfma_f32_16x16x32_bf16 v[180:183], v[28:31], v[68:71], v[180:183]
  v_mfma_f32_16x16x32_bf16 v[184:187], v[20:23], v[76:79], v[184:187]
  v_mfma_f32_16x16x32_bf16 v[188:191], v[28:31], v[76:79], v[188:191]
  s_waitcnt lgkmcnt(4)
  v_mfma_f32_16x16x32_bf16 v[192:195], v[16:19], v[120:123], v[192:195]
  ds_read_b128 v[64:67], v165 offset:12288
  v_mfma_f32_16x16x32_bf16 v[196:199], v[24:27], v[120:123], v[196:199]
  ds_read_b128 v[68:71], v166 offset:12288
  v_mfma_f32_16x16x32_bf16 v[200:203], v[16:19], v[128:131], v[200:203]
  ds_read_b128 v[72:75], v165 offset:14336
  v_mfma_f32_16x16x32_bf16 v[204:207], v[24:27], v[128:131], v[204:207]
  ds_read_b128 v[76:79], v166 offset:14336
  v_mfma_f32_16x16x32_bf16 v[192:195], v[20:23], v[124:127], v[192:195]
  v_mfma_f32_16x16x32_bf16 v[196:199], v[28:31], v[124:127], v[196:199]
  v_mfma_f32_16x16x32_bf16 v[200:203], v[20:23], v[132:135], v[200:203]
  v_mfma_f32_16x16x32_bf16 v[204:207], v[28:31], v[132:135], v[204:207]
  s_waitcnt lgkmcnt(4)
  v_mfma_f32_16x16x32_bf16 v[208:211], v[16:19], v[48:51], v[208:211]
  ds_read_b128 v[120:123], v165 offset:16384
  v_mfma_f32_16x16x32_bf16 v[212:215], v[24:27], v[48:51], v[212:215]
  ds_read_b128 v[124:127], v166 offset:16384
  v_mfma_f32_16x16x32_bf16 v[216:219], v[16:19], v[56:59], v[216:219]
  ds_read_b128 v[128:131], v165 offset:18432
  v_mfma_f32_16x16x32_bf16 v[220:223], v[24:27], v[56:59], v[220:223]
  ds_read_b128 v[132:135], v166 offset:18432
  v_mfma_f32_16x16x32_bf16 v[208:211], v[20:23], v[52:55], v[208:211]
  v_mfma_f32_16x16x32_bf16 v[212:215], v[28:31], v[52:55], v[212:215]
  v_mfma_f32_16x16x32_bf16 v[216:219], v[20:23], v[60:63], v[216:219]
  v_mfma_f32_16x16x32_bf16 v[220:223], v[28:31], v[60:63], v[220:223]
  s_waitcnt lgkmcnt(4)
  v_mfma_f32_16x16x32_bf16 v[224:227], v[16:19], v[64:67], v[224:227]
  v_mfma_f32_16x16x32_bf16 v[228:231], v[24:27], v[64:67], v[228:231]
  v_mfma_f32_16x16x32_bf16 v[232:235], v[16:19], v[72:75], v[232:235]
  v_mfma_f32_16x16x32_bf16 v[236:239], v[24:27], v[72:75], v[236:239]
  v_mfma_f32_16x16x32_bf16 v[224:227], v[20:23], v[68:71], v[224:227]
  v_mfma_f32_16x16x32_bf16 v[228:231], v[28:31], v[68:71], v[228:231]
  v_mfma_f32_16x16x32_bf16 v[232:235], v[20:23], v[76:79], v[232:235]
  v_mfma_f32_16x16x32_bf16 v[236:239], v[28:31], v[76:79], v[236:239]
  s_waitcnt lgkmcnt(0)
  s_barrier
  v_mfma_f32_16x16x32_bf16 v[240:243], v[16:19], v[120:123], v[240:243]
  ds_read_b128 v[32:35], v160 offset:384
  ds_read_b128 v[36:39], v161 offset:384
  v_mfma_f32_16x16x32_bf16 v[244:247], v[24:27], v[120:123], v[244:247]
  ds_read_b128 v[40:43], v160 offset:10624
  ds_read_b128 v[44:47], v161 offset:10624
  v_mfma_f32_16x16x32_bf16 v[248:251], v[16:19], v[128:131], v[248:251]
  ds_read_b128 v[48:51], v162 offset:0
  ds_read_b128 v[52:55], v163 offset:0
  v_mfma_f32_16x16x32_bf16 v[252:255], v[24:27], v[128:131], v[252:255]
  ds_read_b128 v[56:59], v162 offset:2048
  ds_read_b128 v[60:63], v163 offset:2048
  v_mfma_f32_16x16x32_bf16 v[240:243], v[20:23], v[124:127], v[240:243]
  ds_read_b128 v[64:67], v162 offset:4096
  ds_read_b128 v[68:71], v163 offset:4096
  v_mfma_f32_16x16x32_bf16 v[244:247], v[28:31], v[124:127], v[244:247]
  ds_read_b128 v[72:75], v162 offset:6144
  ds_read_b128 v[76:79], v163 offset:6144
  v_mfma_f32_16x16x32_bf16 v[248:251], v[20:23], v[132:135], v[248:251]
  v_mfma_f32_16x16x32_bf16 v[252:255], v[28:31], v[132:135], v[252:255]
  s_waitcnt lgkmcnt(4)
  v_mfma_f32_16x16x32_bf16 v[176:179], v[32:35], v[48:51], v[176:179]
  ds_read_b128 v[120:123], v162 offset:8192
  v_mfma_f32_16x16x32_bf16 v[180:183], v[40:43], v[48:51], v[180:183]
  ds_read_b128 v[124:127], v163 offset:8192
  v_mfma_f32_16x16x32_bf16 v[184:187], v[32:35], v[56:59], v[184:187]
  ds_read_b128 v[128:131], v162 offset:10240
  v_mfma_f32_16x16x32_bf16 v[188:191], v[40:43], v[56:59], v[188:191]
  ds_read_b128 v[132:135], v163 offset:10240
  v_mfma_f32_16x16x32_bf16 v[176:179], v[36:39], v[52:55], v[176:179]
  v_mfma_f32_16x16x32_bf16 v[180:183], v[44:47], v[52:55], v[180:183]
  v_mfma_f32_16x16x32_bf16 v[184:187], v[36:39], v[60:63], v[184:187]
  v_mfma_f32_16x16x32_bf16 v[188:191], v[44:47], v[60:63], v[188:191]
  s_waitcnt lgkmcnt(4)
  v_mfma_f32_16x16x32_bf16 v[192:195], v[32:35], v[64:67], v[192:195]
  ds_read_b128 v[48:51], v162 offset:12288
  v_mfma_f32_16x16x32_bf16 v[196:199], v[40:43], v[64:67], v[196:199]
  ds_read_b128 v[52:55], v163 offset:12288
  v_mfma_f32_16x16x32_bf16 v[200:203], v[32:35], v[72:75], v[200:203]
  ds_read_b128 v[56:59], v162 offset:14336
  v_mfma_f32_16x16x32_bf16 v[204:207], v[40:43], v[72:75], v[204:207]
  ds_read_b128 v[60:63], v163 offset:14336
  v_mfma_f32_16x16x32_bf16 v[192:195], v[36:39], v[68:71], v[192:195]
  v_mfma_f32_16x16x32_bf16 v[196:199], v[44:47], v[68:71], v[196:199]
  v_mfma_f32_16x16x32_bf16 v[200:203], v[36:39], v[76:79], v[200:203]
  v_mfma_f32_16x16x32_bf16 v[204:207], v[44:47], v[76:79], v[204:207]
  s_waitcnt lgkmcnt(4)
  v_mfma_f32_16x16x32_bf16 v[208:211], v[32:35], v[120:123], v[208:211]
  ds_read_b128 v[64:67], v162 offset:16384
  v_mfma_f32_16x16x32_bf16 v[212:215], v[40:43], v[120:123], v[212:215]
  ds_read_b128 v[68:71], v163 offset:16384
  v_mfma_f32_16x16x32_bf16 v[216:219], v[32:35], v[128:131], v[216:219]
  ds_read_b128 v[72:75], v162 offset:18432
  v_mfma_f32_16x16x32_bf16 v[220:223], v[40:43], v[128:131], v[220:223]
  ds_read_b128 v[76:79], v163 offset:18432
  v_mfma_f32_16x16x32_bf16 v[208:211], v[36:39], v[124:127], v[208:211]
  v_mfma_f32_16x16x32_bf16 v[212:215], v[44:47], v[124:127], v[212:215]
  v_mfma_f32_16x16x32_bf16 v[216:219], v[36:39], v[132:135], v[216:219]
  v_mfma_f32_16x16x32_bf16 v[220:223], v[44:47], v[132:135], v[220:223]
  s_waitcnt lgkmcnt(4)
  v_mfma_f32_16x16x32_bf16 v[224:227], v[32:35], v[48:51], v[224:227]
  v_mfma_f32_16x16x32_bf16 v[228:231], v[40:43], v[48:51], v[228:231]
  v_mfma_f32_16x16x32_bf16 v[232:235], v[32:35], v[56:59], v[232:235]
  v_mfma_f32_16x16x32_bf16 v[236:239], v[40:43], v[56:59], v[236:239]
  v_mfma_f32_16x16x32_bf16 v[224:227], v[36:39], v[52:55], v[224:227]
  v_mfma_f32_16x16x32_bf16 v[228:231], v[44:47], v[52:55], v[228:231]
  v_mfma_f32_16x16x32_bf16 v[232:235], v[36:39], v[60:63], v[232:235]
  v_mfma_f32_16x16x32_bf16 v[236:239], v[44:47], v[60:63], v[236:239]
  s_waitcnt lgkmcnt(0)
  s_barrier
  v_mfma_f32_16x16x32_bf16 v[240:243], v[32:35], v[64:67], v[240:243]
  ds_read_b128 v[16:19], v160 offset:512
  ds_read_b128 v[20:23], v161 offset:512
  v_mfma_f32_16x16x32_bf16 v[244:247], v[40:43], v[64:67], v[244:247]
  ds_read_b128 v[24:27], v160 offset:10752
  ds_read_b128 v[28:31], v161 offset:10752
  v_mfma_f32_16x16x32_bf16 v[248:251], v[32:35], v[72:75], v[248:251]
  ds_read_b128 v[120:123], v162 offset:40960
  ds_read_b128 v[124:127], v163 offset:40960
  v_mfma_f32_16x16x32_bf16 v[252:255], v[40:43], v[72:75], v[252:255]
  ds_read_b128 v[128:131], v162 offset:43008
  ds_read_b128 v[132:135], v163 offset:43008
  v_mfma_f32_16x16x32_bf16 v[240:243], v[36:39], v[68:71], v[240:243]
  ds_read_b128 v[48:51], v162 offset:45056
  ds_read_b128 v[52:55], v163 offset:45056
  v_mfma_f32_16x16x32_bf16 v[244:247], v[44:47], v[68:71], v[244:247]
  ds_read_b128 v[56:59], v162 offset:47104
  ds_read_b128 v[60:63], v163 offset:47104
  v_mfma_f32_16x16x32_bf16 v[248:251], v[36:39], v[76:79], v[248:251]
  v_mfma_f32_16x16x32_bf16 v[252:255], v[44:47], v[76:79], v[252:255]
  s_waitcnt lgkmcnt(4)
  v_mfma_f32_16x16x32_bf16 v[176:179], v[16:19], v[120:123], v[176:179]
  ds_read_b128 v[64:67], v162 offset:49152
  v_mfma_f32_16x16x32_bf16 v[180:183], v[24:27], v[120:123], v[180:183]
  ds_read_b128 v[68:71], v163 offset:49152
  v_mfma_f32_16x16x32_bf16 v[184:187], v[16:19], v[128:131], v[184:187]
  ds_read_b128 v[72:75], v162 offset:51200
  v_mfma_f32_16x16x32_bf16 v[188:191], v[24:27], v[128:131], v[188:191]
  ds_read_b128 v[76:79], v163 offset:51200
  v_mfma_f32_16x16x32_bf16 v[176:179], v[20:23], v[124:127], v[176:179]
  v_mfma_f32_16x16x32_bf16 v[180:183], v[28:31], v[124:127], v[180:183]
  v_mfma_f32_16x16x32_bf16 v[184:187], v[20:23], v[132:135], v[184:187]
  v_mfma_f32_16x16x32_bf16 v[188:191], v[28:31], v[132:135], v[188:191]
  s_waitcnt lgkmcnt(4)
  v_mfma_f32_16x16x32_bf16 v[192:195], v[16:19], v[48:51], v[192:195]
  ds_read_b128 v[120:123], v162 offset:53248
  v_mfma_f32_16x16x32_bf16 v[196:199], v[24:27], v[48:51], v[196:199]
  ds_read_b128 v[124:127], v163 offset:53248
  v_mfma_f32_16x16x32_bf16 v[200:203], v[16:19], v[56:59], v[200:203]
  ds_read_b128 v[128:131], v162 offset:55296
  v_mfma_f32_16x16x32_bf16 v[204:207], v[24:27], v[56:59], v[204:207]
  ds_read_b128 v[132:135], v163 offset:55296
  v_mfma_f32_16x16x32_bf16 v[192:195], v[20:23], v[52:55], v[192:195]
  v_mfma_f32_16x16x32_bf16 v[196:199], v[28:31], v[52:55], v[196:199]
  v_mfma_f32_16x16x32_bf16 v[200:203], v[20:23], v[60:63], v[200:203]
  v_mfma_f32_16x16x32_bf16 v[204:207], v[28:31], v[60:63], v[204:207]
  s_waitcnt lgkmcnt(4)
  v_mfma_f32_16x16x32_bf16 v[208:211], v[16:19], v[64:67], v[208:211]
  ds_read_b128 v[48:51], v162 offset:57344
  v_mfma_f32_16x16x32_bf16 v[212:215], v[24:27], v[64:67], v[212:215]
  ds_read_b128 v[52:55], v163 offset:57344
  v_mfma_f32_16x16x32_bf16 v[216:219], v[16:19], v[72:75], v[216:219]
  ds_read_b128 v[56:59], v162 offset:59392
  v_mfma_f32_16x16x32_bf16 v[220:223], v[24:27], v[72:75], v[220:223]
  ds_read_b128 v[60:63], v163 offset:59392
  v_mfma_f32_16x16x32_bf16 v[208:211], v[20:23], v[68:71], v[208:211]
  v_mfma_f32_16x16x32_bf16 v[212:215], v[28:31], v[68:71], v[212:215]
  v_mfma_f32_16x16x32_bf16 v[216:219], v[20:23], v[76:79], v[216:219]
  v_mfma_f32_16x16x32_bf16 v[220:223], v[28:31], v[76:79], v[220:223]
  s_waitcnt lgkmcnt(4)
  v_mfma_f32_16x16x32_bf16 v[224:227], v[16:19], v[120:123], v[224:227]
  v_mfma_f32_16x16x32_bf16 v[228:231], v[24:27], v[120:123], v[228:231]
  v_mfma_f32_16x16x32_bf16 v[232:235], v[16:19], v[128:131], v[232:235]
  v_mfma_f32_16x16x32_bf16 v[236:239], v[24:27], v[128:131], v[236:239]
  v_mfma_f32_16x16x32_bf16 v[224:227], v[20:23], v[124:127], v[224:227]
  v_mfma_f32_16x16x32_bf16 v[228:231], v[28:31], v[124:127], v[228:231]
  v_mfma_f32_16x16x32_bf16 v[232:235], v[20:23], v[132:135], v[232:235]
  v_mfma_f32_16x16x32_bf16 v[236:239], v[28:31], v[132:135], v[236:239]
  s_waitcnt lgkmcnt(0)
  s_barrier
  v_mfma_f32_16x16x32_bf16 v[240:243], v[16:19], v[48:51], v[240:243]
  v_mfma_f32_16x16x32_bf16 v[244:247], v[24:27], v[48:51], v[244:247]
  v_mfma_f32_16x16x32_bf16 v[248:251], v[16:19], v[56:59], v[248:251]
  v_mfma_f32_16x16x32_bf16 v[252:255], v[24:27], v[56:59], v[252:255]
  v_mfma_f32_16x16x32_bf16 v[240:243], v[20:23], v[52:55], v[240:243]
  v_mfma_f32_16x16x32_bf16 v[244:247], v[28:31], v[52:55], v[244:247]
  v_mfma_f32_16x16x32_bf16 v[248:251], v[20:23], v[60:63], v[248:251]
  v_mfma_f32_16x16x32_bf16 v[252:255], v[28:31], v[60:63], v[252:255]
  s_nop 7
  v_cvt_pk_bf16_f32 v104, v176, v177
  v_cvt_pk_bf16_f32 v105, v178, v179
  v_cvt_pk_bf16_f32 v106, v180, v181
  v_cvt_pk_bf16_f32 v107, v182, v183
  v_cvt_pk_bf16_f32 v108, v184, v185
  v_cvt_pk_bf16_f32 v109, v186, v187
  v_cvt_pk_bf16_f32 v110, v188, v189
  v_cvt_pk_bf16_f32 v111, v190, v191
  s_nop 1
  v_mfma_f32_16x16x32_bf16 v[80:83], v[136:139], v[104:107], 0
  v_mfma_f32_16x16x32_bf16 v[84:87], v[144:147], v[104:107], 0
  v_mfma_f32_16x16x32_bf16 v[88:91], v[140:143], v[104:107], 0
  v_mfma_f32_16x16x32_bf16 v[92:95], v[148:151], v[104:107], 0
  v_mfma_f32_16x16x32_bf16 v[80:83], v[152:155], v[108:111], v[80:83]
  v_mfma_f32_16x16x32_bf16 v[84:87], v[136:139], v[108:111], v[84:87]
  v_mfma_f32_16x16x32_bf16 v[88:91], v[156:159], v[108:111], v[88:91]
  v_mfma_f32_16x16x32_bf16 v[92:95], v[140:143], v[108:111], v[92:95]
  v_cvt_pk_bf16_f32 v112, v192, v193
  v_cvt_pk_bf16_f32 v113, v194, v195
  v_cvt_pk_bf16_f32 v114, v196, v197
  v_cvt_pk_bf16_f32 v115, v198, v199
  v_cvt_pk_bf16_f32 v116, v200, v201
  v_cvt_pk_bf16_f32 v117, v202, v203
  v_cvt_pk_bf16_f32 v118, v204, v205
  v_cvt_pk_bf16_f32 v119, v206, v207
  s_nop 1
  v_mfma_f32_16x16x32_bf16 v[120:123], v[136:139], v[112:115], 0
  v_mfma_f32_16x16x32_bf16 v[124:127], v[144:147], v[112:115], 0
  v_mfma_f32_16x16x32_bf16 v[128:131], v[140:143], v[112:115], 0
  v_mfma_f32_16x16x32_bf16 v[132:135], v[148:151], v[112:115], 0
  v_mfma_f32_16x16x32_bf16 v[120:123], v[152:155], v[116:119], v[120:123]
  v_mfma_f32_16x16x32_bf16 v[124:127], v[136:139], v[116:119], v[124:127]
  v_mfma_f32_16x16x32_bf16 v[128:131], v[156:159], v[116:119], v[128:131]
  v_mfma_f32_16x16x32_bf16 v[132:135], v[140:143], v[116:119], v[132:135]
  v_cvt_pk_bf16_f32 v80, v80, v84
  v_cvt_pk_bf16_f32 v81, v81, v85
  v_cvt_pk_bf16_f32 v82, v82, v86
  v_cvt_pk_bf16_f32 v83, v83, v87
  v_cvt_pk_bf16_f32 v88, v88, v92
  v_cvt_pk_bf16_f32 v89, v89, v93
  v_cvt_pk_bf16_f32 v90, v90, v94
  v_cvt_pk_bf16_f32 v91, v91, v95
  ds_write_b32 v164, v80 offset:0
  ds_write_b32 v164, v81 offset:640
  ds_write_b32 v164, v82 offset:1280
  ds_write_b32 v164, v83 offset:1920
  ds_write_b32 v164, v88 offset:10240
  ds_write_b32 v164, v89 offset:10880
  ds_write_b32 v164, v90 offset:11520
  ds_write_b32 v164, v91 offset:12160
  v_cvt_pk_bf16_f32 v104, v208, v209
  v_cvt_pk_bf16_f32 v105, v210, v211
  v_cvt_pk_bf16_f32 v106, v212, v213
  v_cvt_pk_bf16_f32 v107, v214, v215
  v_cvt_pk_bf16_f32 v108, v216, v217
  v_cvt_pk_bf16_f32 v109, v218, v219
  v_cvt_pk_bf16_f32 v110, v220, v221
  v_cvt_pk_bf16_f32 v111, v222, v223
  s_nop 1
  v_mfma_f32_16x16x32_bf16 v[80:83], v[136:139], v[104:107], 0
  v_mfma_f32_16x16x32_bf16 v[84:87], v[144:147], v[104:107], 0
  v_mfma_f32_16x16x32_bf16 v[88:91], v[140:143], v[104:107], 0
  v_mfma_f32_16x16x32_bf16 v[92:95], v[148:151], v[104:107], 0
  v_mfma_f32_16x16x32_bf16 v[80:83], v[152:155], v[108:111], v[80:83]
  v_mfma_f32_16x16x32_bf16 v[84:87], v[136:139], v[108:111], v[84:87]
  v_mfma_f32_16x16x32_bf16 v[88:91], v[156:159], v[108:111], v[88:91]
  v_mfma_f32_16x16x32_bf16 v[92:95], v[140:143], v[108:111], v[92:95]
  v_cvt_pk_bf16_f32 v120, v120, v124
  v_cvt_pk_bf16_f32 v121, v121, v125
  v_cvt_pk_bf16_f32 v122, v122, v126
  v_cvt_pk_bf16_f32 v123, v123, v127
  v_cvt_pk_bf16_f32 v128, v128, v132
  v_cvt_pk_bf16_f32 v129, v129, v133
  v_cvt_pk_bf16_f32 v130, v130, v134
  v_cvt_pk_bf16_f32 v131, v131, v135
  ds_write_b32 v164, v120 offset:64
  ds_write_b32 v164, v121 offset:704
  ds_write_b32 v164, v122 offset:1344
  ds_write_b32 v164, v123 offset:1984
  ds_write_b32 v164, v128 offset:10304
  ds_write_b32 v164, v129 offset:10944
  ds_write_b32 v164, v130 offset:11584
  ds_write_b32 v164, v131 offset:12224
  v_cvt_pk_bf16_f32 v112, v224, v225
  v_cvt_pk_bf16_f32 v113, v226, v227
  v_cvt_pk_bf16_f32 v114, v228, v229
  v_cvt_pk_bf16_f32 v115, v230, v231
  v_cvt_pk_bf16_f32 v116, v232, v233
  v_cvt_pk_bf16_f32 v117, v234, v235
  v_cvt_pk_bf16_f32 v118, v236, v237
  v_cvt_pk_bf16_f32 v119, v238, v239
  s_nop 1
  v_mfma_f32_16x16x32_bf16 v[120:123], v[136:139], v[112:115], 0
  v_mfma_f32_16x16x32_bf16 v[124:127], v[144:147], v[112:115], 0
  v_mfma_f32_16x16x32_bf16 v[128:131], v[140:143], v[112:115], 0
  v_mfma_f32_16x16x32_bf16 v[132:135], v[148:151], v[112:115], 0
  v_mfma_f32_16x16x32_bf16 v[120:123], v[152:155], v[116:119], v[120:123]
  v_mfma_f32_16x16x32_bf16 v[124:127], v[136:139], v[116:119], v[124:127]
  v_mfma_f32_16x16x32_bf16 v[128:131], v[156:159], v[116:119], v[128:131]
  v_mfma_f32_16x16x32_bf16 v[132:135], v[140:143], v[116:119], v[132:135]
  v_cvt_pk_bf16_f32 v80, v80, v84
  v_cvt_pk_bf16_f32 v81, v81, v85
  v_cvt_pk_bf16_f32 v82, v82, v86
  v_cvt_pk_bf16_f32 v83, v83, v87
  v_cvt_pk_bf16_f32 v88, v88, v92
  v_cvt_pk_bf16_f32 v89, v89, v93
  v_cvt_pk_bf16_f32 v90, v90, v94
  v_cvt_pk_bf16_f32 v91, v91, v95
  ds_write_b32 v164, v80 offset:128
  ds_write_b32 v164, v81 offset:768
  ds_write_b32 v164, v82 offset:1408
  ds_write_b32 v164, v83 offset:2048
  ds_write_b32 v164, v88 offset:10368
  ds_write_b32 v164, v89 offset:11008
  ds_write_b32 v164, v90 offset:11648
  ds_write_b32 v164, v91 offset:12288
  v_cvt_pk_bf16_f32 v104, v240, v241
  v_cvt_pk_bf16_f32 v105, v242, v243
  v_cvt_pk_bf16_f32 v106, v244, v245
  v_cvt_pk_bf16_f32 v107, v246, v247
  v_cvt_pk_bf16_f32 v108, v248, v249
  v_cvt_pk_bf16_f32 v109, v250, v251
  v_cvt_pk_bf16_f32 v110, v252, v253
  v_cvt_pk_bf16_f32 v111, v254, v255
  s_nop 1
  v_mfma_f32_16x16x32_bf16 v[80:83], v[136:139], v[104:107], 0
  v_mfma_f32_16x16x32_bf16 v[84:87], v[144:147], v[104:107], 0
  v_mfma_f32_16x16x32_bf16 v[88:91], v[140:143], v[104:107], 0
  v_mfma_f32_16x16x32_bf16 v[92:95], v[148:151], v[104:107], 0
  v_mfma_f32_16x16x32_bf16 v[80:83], v[152:155], v[108:111], v[80:83]
  v_mfma_f32_16x16x32_bf16 v[84:87], v[136:139], v[108:111], v[84:87]
  v_mfma_f32_16x16x32_bf16 v[88:91], v[156:159], v[108:111], v[88:91]
  v_mfma_f32_16x16x32_bf16 v[92:95], v[140:143], v[108:111], v[92:95]
  v_cvt_pk_bf16_f32 v120, v120, v124
  v_cvt_pk_bf16_f32 v121, v121, v125
  v_cvt_pk_bf16_f32 v122, v122, v126
  v_cvt_pk_bf16_f32 v123, v123, v127
  v_cvt_pk_bf16_f32 v128, v128, v132
  v_cvt_pk_bf16_f32 v129, v129, v133
  v_cvt_pk_bf16_f32 v130, v130, v134
  v_cvt_pk_bf16_f32 v131, v131, v135
  ds_write_b32 v164, v120 offset:192
  ds_write_b32 v164, v121 offset:832
  ds_write_b32 v164, v122 offset:1472
  ds_write_b32 v164, v123 offset:2112
  ds_write_b32 v164, v128 offset:10432
  ds_write_b32 v164, v129 offset:11072
  ds_write_b32 v164, v130 offset:11712
  ds_write_b32 v164, v131 offset:12352
  s_nop 7
  v_cvt_pk_bf16_f32 v80, v80, v84
  v_cvt_pk_bf16_f32 v81, v81, v85
  v_cvt_pk_bf16_f32 v82, v82, v86
  v_cvt_pk_bf16_f32 v83, v83, v87
  v_cvt_pk_bf16_f32 v88, v88, v92
  v_cvt_pk_bf16_f32 v89, v89, v93
  v_cvt_pk_bf16_f32 v90, v90, v94
  v_cvt_pk_bf16_f32 v91, v91, v95
  ds_write_b32 v164, v80 offset:256
  ds_write_b32 v164, v81 offset:896
  ds_write_b32 v164, v82 offset:1536
  ds_write_b32 v164, v83 offset:2176
  ds_write_b32 v164, v88 offset:10496
  ds_write_b32 v164, v89 offset:11136
  ds_write_b32 v164, v90 offset:11776
  ds_write_b32 v164, v91 offset:12416
L_F_copy:
  s_waitcnt lgkmcnt(0)
  s_barrier
  v_lshlrev_b32 v6, 4, v1
  s_mul_i32 s56, s52, 5120
  s_add_u32 s56, s56, 122880
  v_add_u32 v7, s56, v6
  v_add_u32 v8, 0x1000, v6
  ds_read_b128 v[16:19], v7 offset:0
  ds_read_b128 v[20:23], v7 offset:1024
  ds_read_b128 v[24:27], v7 offset:2048
  ds_read_b128 v[28:31], v7 offset:3072
  ds_read_b128 v[32:35], v7 offset:4096
  s_lshr_b32 s56, s52, 2
  s_lshl_b32 s56, s56, 5
  s_add_u32 s56, s56, s53
  s_mul_i32 s56, s56, 20480
  s_mul_i32 s57, s55, 1310720
  s_add_u32 s56, s56, s57
  s_mul_i32 s57, s63, 5120
  s_add_u32 s56, s56, s57
  s_waitcnt lgkmcnt(4)
  buffer_store_dwordx4 v[16:19], v6, s[32:35], s56 offen offset:0 sc1
  s_waitcnt lgkmcnt(3)
  buffer_store_dwordx4 v[20:23], v6, s[32:35], s56 offen offset:1024 sc1
  s_waitcnt lgkmcnt(2)
  buffer_store_dwordx4 v[24:27], v6, s[32:35], s56 offen offset:2048 sc1
  s_waitcnt lgkmcnt(1)
  buffer_store_dwordx4 v[28:31], v6, s[32:35], s56 offen offset:3072 sc1
  s_waitcnt lgkmcnt(0)
  buffer_store_dwordx4 v[32:35], v8, s[32:35], s56 offen sc1
  s_waitcnt vmcnt(0)
  s_barrier
  s_cmp_ge_u32 s52, 4
  s_cbranch_scc0 L_K2_cons
  s_cmp_lg_u32 s52, 4
  s_cbranch_scc1 L_F_rest
  s_lshl_b32 s50, s53, 1
  s_add_u32 s50, s50, s55
  s_lshl_b32 s50, s50, 7
  s_add_u32 s50, s50, 131072
  v_mov_b32 v6, s50
  v_mov_b32 v7, s48
  s_mov_b64 exec, 1
  buffer_store_dword v7, v6, s[96:99], 0 offen sc1
  s_mov_b64 exec, -1
L_F_rest:
  s_add_u32 s40, s20, 8388608
  s_addc_u32 s41, s21, 0
  s_mov_b32 s42, 2211840
  s_mov_b32 s43, 0x00020000
  s_mul_i32 s56, s63, 14
  s_cmp_eq_u32 s63, 3
  s_cselect_b32 s57, 1, 0
  s_sub_u32 s56, s56, s57
  s_mul_i32 s57, s44, 54
  s_add_u32 s57, s57, s56
  s_mul_i32 s61, s57, 5120
  s_mul_i32 s62, s63, 5120
  v_lshlrev_b32 v11, 4, v1
  s_add_u32 m0, s62, 122880
  s_add_u32 s56, s61, 30720
  buffer_load_dwordx4 v11, s[40:43], s56 offen sc1 lds
  s_add_u32 m0, s62, 123904
  s_add_u32 s56, s61, 31744
  buffer_load_dwordx4 v11, s[40:43], s56 offen sc1 lds
  s_add_u32 m0, s62, 124928
  s_add_u32 s56, s61, 32768
  buffer_load_dwordx4 v11, s[40:43], s56 offen sc1 lds
  s_add_u32 m0, s62, 125952
  s_add_u32 s56, s61, 33792
  buffer_load_dwordx4 v11, s[40:43], s56 offen sc1 lds
  s_add_u32 m0, s62, 126976
  s_add_u32 s56, s61, 34816
  buffer_load_dwordx4 v11, s[40:43], s56 offen sc1 lds
  s_add_u32 m0, s62, 143360
  s_add_u32 s56, s61, 35840
  buffer_load_dwordx4 v11, s[40:43], s56 offen sc1 lds
  s_add_u32 m0, s62, 144384
  s_add_u32 s56, s61, 36864
  buffer_load_dwordx4 v11, s[40:43], s56 offen sc1 lds
  s_add_u32 m0, s62, 145408
  s_add_u32 s56, s61, 37888
  buffer_load_dwordx4 v11, s[40:43], s56 offen sc1 lds
  s_add_u32 m0, s62, 146432
  s_add_u32 s56, s61, 38912
  buffer_load_dwordx4 v11, s[40:43], s56 offen sc1 lds
  s_add_u32 m0, s62, 147456
  s_add_u32 s56, s61, 39936
  buffer_load_dwordx4 v11, s[40:43], s56 offen sc1 lds
  s_branch L_K2_poll
L_h_done:
  s_barrier
  s_waitcnt vmcnt(0)
  s_mov_b32 s51, 131072
L_nonce_13:
  v_readfirstlane_b32 s48, v130
  s_nop 3
  s_cmp_lg_u32 s48, 0
  s_cbranch_scc1 L_nonce_ok_14
  s_sub_u32 s51, s51, 1
  s_cmp_eq_u32 s51, 0
  s_cbranch_scc1 L_nonce_ok_14
  s_sleep 1
  v_mov_b32 v6, 0
  buffer_load_dword v130, v6, s[92:95], 0 offen sc1
  s_waitcnt vmcnt(0)
  s_branch L_nonce_13
L_nonce_ok_14:
  s_lshl_b32 s50, s49, 2
  s_add_u32 s50, s50, s52
  s_mul_i32 s51, s53, 24
  s_add_u32 s50, s50, s51
  s_lshl_b32 s50, s50, 7
  v_mov_b32 v6, s50
  v_mov_b32 v7, s48
  s_mov_b64 exec, 1
  buffer_store_dword v7, v6, s[96:99], 0 offen sc1
  s_mov_b64 exec, -1
  s_branch L_K2_cons
L_K2_dma:
  s_add_u32 s40, s20, 8388608
  s_addc_u32 s41, s21, 0
  s_mov_b32 s42, 2211840
  s_mov_b32 s43, 0x00020000
  s_mul_i32 s56, s63, 14
  s_cmp_eq_u32 s63, 3
  s_cselect_b32 s57, 1, 0
  s_sub_u32 s56, s56, s57
  s_mul_i32 s57, s44, 54
  s_add_u32 s57, s57, s56
  s_mul_i32 s61, s57, 5120
  s_mul_i32 s62, s63, 5120
  v_lshlrev_b32 v11, 4, v1
  s_add_u32 m0, s62, 0
  s_add_u32 s56, s61, 0
  buffer_load_dwordx4 v11, s[40:43], s56 offen sc1 lds
  s_add_u32 m0, s62, 1024
  s_add_u32 s56, s61, 1024
  buffer_load_dwordx4 v11, s[40:43], s56 offen sc1 lds
  s_add_u32 m0, s62, 2048
  s_add_u32 s56, s61, 2048
  buffer_load_dwordx4 v11, s[40:43], s56 offen sc1 lds
  s_add_u32 m0, s62, 3072
  s_add_u32 s56, s61, 3072
  buffer_load_dwordx4 v11, s[40:43], s56 offen sc1 lds
  s_add_u32 m0, s62, 4096
  s_add_u32 s56, s61, 4096
  buffer_load_dwordx4 v11, s[40:43], s56 offen sc1 lds
  s_add_u32 m0, s62, 20480
  s_add_u32 s56, s61, 5120
  buffer_load_dwordx4 v11, s[40:43], s56 offen sc1 lds
  s_add_u32 m0, s62, 21504
  s_add_u32 s56, s61, 6144
  buffer_load_dwordx4 v11, s[40:43], s56 offen sc1 lds
  s_add_u32 m0, s62, 22528
  s_add_u32 s56, s61, 7168
  buffer_load_dwordx4 v11, s[40:43], s56 offen sc1 lds
  s_add_u32 m0, s62, 23552
  s_add_u32 s56, s61, 8192
  buffer_load_dwordx4 v11, s[40:43], s56 offen sc1 lds
  s_add_u32 m0, s62, 24576
  s_add_u32 s56, s61, 9216
  buffer_load_dwordx4 v11, s[40:43], s56 offen sc1 lds
  s_add_u32 m0, s62, 40960
  s_add_u32 s56, s61, 10240
  buffer_load_dwordx4 v11, s[40:43], s56 offen sc1 lds
  s_add_u32 m0, s62, 41984
  s_add_u32 s56, s61, 11264
  buffer_load_dwordx4 v11, s[40:43], s56 offen sc1 lds
  s_add_u32 m0, s62, 43008
  s_add_u32 s56, s61, 12288
  buffer_load_dwordx4 v11, s[40:43], s56 offen sc1 lds
  s_add_u32 m0, s62, 44032
  s_add_u32 s56, s61, 13312
  buffer_load_dwordx4 v11, s[40:43], s56 offen sc1 lds
  s_add_u32 m0, s62, 45056
  s_add_u32 s56, s61, 14336
  buffer_load_dwordx4 v11, s[40:43], s56 offen sc1 lds
  s_add_u32 m0, s62, 61440
  s_add_u32 s56, s61, 15360
  buffer_load_dwordx4 v11, s[40:43], s56 offen sc1 lds
  s_add_u32 m0, s62, 62464
  s_add_u32 s56, s61, 16384
  buffer_load_dwordx4 v11, s[40:43], s56 offen sc1 lds
  s_add_u32 m0, s62, 63488
  s_add_u32 s56, s61, 17408
  buffer_load_dwordx4 v11, s[40:43], s56 offen sc1 lds
  s_add_u32 m0, s62, 64512
  s_add_u32 s56, s61, 18432
  buffer_load_dwordx4 v11, s[40:43], s56 offen sc1 lds
  s_add_u32 m0, s62, 65536
  s_add_u32 s56, s61, 19456
  buffer_load_dwordx4 v11, s[40:43], s56 offen sc1 lds
  s_add_u32 m0, s62, 81920
  s_add_u32 s56, s61, 20480
  buffer_load_dwordx4 v11, s[40:43], s56 offen sc1 lds
  s_add_u32 m0, s62, 82944
  s_add_u32 s56, s61, 21504
  buffer_load_dwordx4 v11, s[40:43], s56 offen sc1 lds
  s_add_u32 m0, s62, 83968
  s_add_u32 s56, s61, 22528
  buffer_load_dwordx4 v11, s[40:43], s56 offen sc1 lds
  s_add_u32 m0, s62, 84992
  s_add_u32 s56, s61, 23552
  buffer_load_dwordx4 v11, s[40:43], s56 offen sc1 lds
  s_add_u32 m0, s62, 86016
  s_add_u32 s56, s61, 24576
  buffer_load_dwordx4 v11, s[40:43], s56 offen sc1 lds
  s_add_u32 m0, s62, 102400
  s_add_u32 s56, s61, 25600
  buffer_load_dwordx4 v11, s[40:43], s56 offen sc1 lds
  s_add_u32 m0, s62, 103424
  s_add_u32 s56, s61, 26624
  buffer_load_dwordx4 v11, s[40:43], s56 offen sc1 lds
  s_add_u32 m0, s62, 104448
  s_add_u32 s56, s61, 27648
  buffer_load_dwordx4 v11, s[40:43], s56 offen sc1 lds
  s_add_u32 m0, s62, 105472
  s_add_u32 s56, s61, 28672
  buffer_load_dwordx4 v11, s[40:43], s56 offen sc1 lds
  s_add_u32 m0, s62, 106496
  s_add_u32 s56, s61, 29696
  buffer_load_dwordx4 v11, s[40:43], s56 offen sc1 lds
  s_add_u32 m0, s62, 122880
  s_add_u32 s56, s61, 30720
  buffer_load_dwordx4 v11, s[40:43], s56 offen sc1 lds
  s_add_u32 m0, s62, 123904
  s_add_u32 s56, s61, 31744
  buffer_load_dwordx4 v11, s[40:43], s56 offen sc1 lds
  s_add_u32 m0, s62, 124928
  s_add_u32 s56, s61, 32768
  buffer_load_dwordx4 v11, s[40:43], s56 offen sc1 lds
  s_add_u32 m0, s62, 125952
  s_add_u32 s56, s61, 33792
  buffer_load_dwordx4 v11, s[40:43], s56 offen sc1 lds
  s_add_u32 m0, s62, 126976
  s_add_u32 s56, s61, 34816
  buffer_load_dwordx4 v11, s[40:43], s56 offen sc1 lds
  s_add_u32 m0, s62, 143360
  s_add_u32 s56, s61, 35840
  buffer_load_dwordx4 v11, s[40:43], s56 offen sc1 lds
  s_add_u32 m0, s62, 144384
  s_add_u32 s56, s61, 36864
  buffer_load_dwordx4 v11, s[40:43], s56 offen sc1 lds
  s_add_u32 m0, s62, 145408
  s_add_u32 s56, s61, 37888
  buffer_load_dwordx4 v11, s[40:43], s56 offen sc1 lds
  s_add_u32 m0, s62, 146432
  s_add_u32 s56, s61, 38912
  buffer_load_dwordx4 v11, s[40:43], s56 offen sc1 lds
  s_add_u32 m0, s62, 147456
  s_add_u32 s56, s61, 39936
  buffer_load_dwordx4 v11, s[40:43], s56 offen sc1 lds
L_K2_poll:
  s_cmp_lg_u32 s52, 4
  s_cbranch_scc1 L_K2_w
  v_min_u32 v7, 23, v1
  s_mul_i32 s56, s100, 24
  v_add_u32 v7, s56, v7
  v_lshlrev_b32 v7, 7, v7
  s_mov_b32 s51, 131072
L_poll_15:
  buffer_load_dword v10, v7, s[96:99], 0 offen sc1
  s_waitcnt vmcnt(0)
  v_cmp_ne_u32 vcc, s48, v10
  s_nop 1
  s_mov_b32 s50, vcc_lo
  s_or_b32 s50, s50, vcc_hi
  s_cmp_eq_u32 s50, 0
  s_cbranch_scc1 L_poll_ok_16
  s_sub_u32 s51, s51, 1
  s_cmp_eq_u32 s51, 0
  s_cbranch_scc1 L_poll_ok_16
  s_sleep 1
  s_branch L_poll_15
L_poll_ok_16:
L_K2_w:
  s_waitcnt vmcnt(0)
L_K2_w2:
  s_barrier
  s_cmp_lg_u32 s52, 4
  s_cbranch_scc1 L_K2_x3
  v_lshlrev_b32 v8, 7, v1
  v_add_u32 v8, 131072, v8
  s_mov_b32 s51, 131072
L_poll_17:
  buffer_load_dword v10, v8, s[96:99], 0 offen sc1
  s_waitcnt vmcnt(0)
  v_cmp_ne_u32 vcc, s48, v10
  s_nop 1
  s_mov_b32 s50, vcc_lo
  s_or_b32 s50, s50, vcc_hi
  s_cmp_eq_u32 s50, 0
  s_cbranch_scc1 L_poll_ok_18
  s_sub_u32 s51, s51, 1
  s_cmp_eq_u32 s51, 0
  s_cbranch_scc1 L_poll_ok_18
  s_sleep 1
  s_branch L_poll_17
L_poll_ok_18:
L_K2_x3:
  s_barrier
  s_endpgm
L_K2_cons:
  s_add_u32 s32, s20, 0
  s_addc_u32 s33, s21, 0
  s_mov_b32 s34, 7077888
  s_mov_b32 s35, 0x00020000
  s_add_u32 s40, s20, 8388608
  s_addc_u32 s41, s21, 0
  s_mov_b32 s42, 2211840
  s_mov_b32 s43, 0x00020000
  s_add_u32 s36, s20, 12582912
  s_addc_u32 s37, s21, 0
  s_mov_b32 s38, 2621440
  s_mov_b32 s39, 0x00020000
  s_mov_b32 s28, s8
  s_mov_b32 s29, s9
  s_mov_b32 s30, 2621440
  s_mov_b32 s31, 0x00020000
  v_lshlrev_b32 v6, 4, v1
  v_add_u32 v7, 0x1000, v6
  s_mul_i32 s50, s52, 5120
  v_add_u32 v14, s50, v6
  v_add_u32 v15, 61440, v14
  v_add_u32 v172, 122880, v14
  s_mul_i32 s50, s52, 14
  s_cmp_eq_u32 s52, 3
  s_cselect_b32 s51, 1, 0
  s_sub_u32 s50, s50, s51
  s_mul_i32 s51, s100, 54
  s_add_u32 s51, s51, s50
  s_lshl_b32 s60, s51, 12
  s_mul_i32 s51, s44, 54
  s_add_u32 s51, s51, s50
  s_add_u32 s51, s51, 8
  s_mul_i32 s61, s51, 5120
  s_mul_i32 s50, s44, 80
  v_add_u32 v173, s50, v4
  v_add_u32 v173, 0, v173
  v_sub_u32 v174, 640, v173
  s_cmp_eq_u32 s45, 1
  s_cselect_b64 vcc, -1, 0
  v_cndmask_b32 v173, v173, v174, vcc
  v_and_b32 v174, 1, v173
  v_lshrrev_b32 v175, 1, v173
  v_add_u32 v175, v175, v174
  v_add_u32 v175, -1, v175
  v_lshlrev_b32 v175, 2, v175
  v_mul_u32_u24 v174, 1310720, v174
  v_add_u32 v175, v175, v174
  v_mul_u32_u24 v174, 81920, v5
  v_add_u32 v175, v175, v174
  v_mov_b32 v174, 2147418112
  v_cmp_eq_u32 vcc, 0, v173
  s_nop 1
  v_cndmask_b32 v8, v175, v174, vcc
  v_add_u32 v173, s50, v4
  v_add_u32 v173, 16, v173
  v_sub_u32 v174, 640, v173
  s_cmp_eq_u32 s45, 1
  s_cselect_b64 vcc, -1, 0
  v_cndmask_b32 v173, v173, v174, vcc
  v_and_b32 v174, 1, v173
  v_lshrrev_b32 v175, 1, v173
  v_add_u32 v175, v175, v174
  v_add_u32 v175, -1, v175
  v_lshlrev_b32 v175, 2, v175
  v_mul_u32_u24 v174, 1310720, v174
  v_add_u32 v175, v175, v174
  v_mul_u32_u24 v174, 81920, v5
  v_add_u32 v175, v175, v174
  v_mov_b32 v174, 2147418112
  v_cmp_eq_u32 vcc, 0, v173
  s_nop 1
  v_cndmask_b32 v9, v175, v174, vcc
  v_add_u32 v173, s50, v4
  v_add_u32 v173, 32, v173
  v_sub_u32 v174, 640, v173
  s_cmp_eq_u32 s45, 1
  s_cselect_b64 vcc, -1, 0
  v_cndmask_b32 v173, v173, v174, vcc
  v_and_b32 v174, 1, v173
  v_lshrrev_b32 v175, 1, v173
  v_add_u32 v175, v175, v174
  v_add_u32 v175, -1, v175
  v_lshlrev_b32 v175, 2, v175
  v_mul_u32_u24 v174, 1310720, v174
  v_add_u32 v175, v175, v174
  v_mul_u32_u24 v174, 81920, v5
  v_add_u32 v175, v175, v174
  v_mov_b32 v174, 2147418112
  v_cmp_eq_u32 vcc, 0, v173
  s_nop 1
  v_cndmask_b32 v10, v175, v174, vcc
  v_add_u32 v173, s50, v4
  v_add_u32 v173, 48, v173
  v_sub_u32 v174, 640, v173
  s_cmp_eq_u32 s45, 1
  s_cselect_b64 vcc, -1, 0
  v_cndmask_b32 v173, v173, v174, vcc
  v_and_b32 v174, 1, v173
  v_lshrrev_b32 v175, 1, v173
  v_add_u32 v175, v175, v174
  v_add_u32 v175, -1, v175
  v_lshlrev_b32 v175, 2, v175
  v_mul_u32_u24 v174, 1310720, v174
  v_add_u32 v175, v175, v174
  v_mul_u32_u24 v174, 81920, v5
  v_add_u32 v175, v175, v174
  v_mov_b32 v174, 2147418112
  v_cmp_eq_u32 vcc, 0, v173
  s_nop 1
  v_cndmask_b32 v11, v175, v174, vcc
  v_add_u32 v173, s50, v4
  v_add_u32 v173, 64, v173
  v_sub_u32 v174, 640, v173
  s_cmp_eq_u32 s45, 1
  s_cselect_b64 vcc, -1, 0
  v_cndmask_b32 v173, v173, v174, vcc
  v_and_b32 v174, 1, v173
  v_lshrrev_b32 v175, 1, v173
  v_add_u32 v175, v175, v174
  v_add_u32 v175, -1, v175
  v_lshlrev_b32 v175, 2, v175
  v_mul_u32_u24 v174, 1310720, v174
  v_add_u32 v175, v175, v174
  v_mul_u32_u24 v174, 81920, v5
  v_add_u32 v175, v175, v174
  v_mov_b32 v174, 2147418112
  v_cmp_eq_u32 vcc, 0, v173
  s_nop 1
  v_cndmask_b32 v12, v175, v174, vcc
  v_mul_u32_u24 v13, 81920, v4
  v_lshlrev_b32 v173, 3, v5
  v_add_u32 v13, v13, v173
  s_lshl_b32 s50, s52, 4
  s_mul_i32 s50, s50, 20480
  s_mul_i32 s51, s46, 640
  s_add_u32 s56, s50, s51
  s_add_u32 s57, s56, 20480
  s_add_u32 s58, s56, 40960
  s_add_u32 s59, s56, 61440
  s_lshr_b32 s50, s52, 1
  s_lshl_b32 s50, s50, 5
  s_and_b32 s51, s52, 1
  s_lshl_b32 s51, s51, 10
  s_add_u32 s50, s50, s51
  s_add_u32 s50, s50, s100
  s_mul_i32 s50, s50, 1280
  s_mul_i32 s51, s44, 160
  s_add_u32 s62, s50, s51
  s_mov_b32 s51, 0x3a000000
  s_cmp_eq_u32 s45, 1
  s_cselect_b32 s51, 0xba000000, s51
  s_lshl_b32 s50, s52, 4
  v_lshl_add_u32 v88, v5, 2, s50
  v_lshl_add_u32 v89, v4, 6, s100
  s_xor_b32 s50, s52, 0
  s_lshl_b32 s66, s50, 10
  s_and_b32 s65, s50, 1
  s_lshl_b32 s65, s65, 10
  s_lshr_b32 s50, s50, 1
  s_lshl_b32 s50, s50, 5
  s_add_u32 s50, s50, s65
  v_add_u32 v90, s50, v89
  v_add_u32 v80, 0, v88
  v_add_u32 v81, 1, v88
  v_add_u32 v82, 2, v88
  v_add_u32 v83, 3, v88
  v_mul_u32_u24 v80, v80, v90
  v_mul_u32_u24 v81, v81, v90
  v_mul_u32_u24 v82, v82, v90
  v_mul_u32_u24 v83, v83, v90
  v_and_b32 v80, 0x7ff, v80
  v_and_b32 v81, 0x7ff, v81
  v_and_b32 v82, 0x7ff, v82
  v_and_b32 v83, 0x7ff, v83
  v_cvt_f32_u32 v80, v80
  v_cvt_f32_u32 v81, v81
  v_cvt_f32_u32 v82, v82
  v_cvt_f32_u32 v83, v83
  v_mul_f32 v80, s51, v80
  v_mul_f32 v81, s51, v81
  v_mul_f32 v82, s51, v82
  v_mul_f32 v83, s51, v83
  v_sin_f32 v84, v80
  v_sin_f32 v85, v81
  v_sin_f32 v86, v82
  v_sin_f32 v87, v83
  v_cos_f32 v80, v80
  v_cos_f32 v81, v81
  v_cos_f32 v82, v82
  v_cos_f32 v83, v83
  s_nop 0
  v_cvt_pk_bf16_f32 v156, v80, v84
  v_cvt_pk_bf16_f32 v157, v81, v85
  v_cvt_pk_bf16_f32 v158, v82, v86
  v_cvt_pk_bf16_f32 v159, v83, v87
  s_xor_b32 s50, s52, 1
  s_lshl_b32 s67, s50, 10
  s_and_b32 s65, s50, 1
  s_lshl_b32 s65, s65, 10
  s_lshr_b32 s50, s50, 1
  s_lshl_b32 s50, s50, 5
  s_add_u32 s50, s50, s65
  v_add_u32 v90, s50, v89
  v_add_u32 v80, 0, v88
  v_add_u32 v81, 1, v88
  v_add_u32 v82, 2, v88
  v_add_u32 v83, 3, v88
  v_mul_u32_u24 v80, v80, v90
  v_mul_u32_u24 v81, v81, v90
  v_mul_u32_u24 v82, v82, v90
  v_mul_u32_u24 v83, v83, v90
  v_and_b32 v80, 0x7ff, v80
  v_and_b32 v81, 0x7ff, v81
  v_and_b32 v82, 0x7ff, v82
  v_and_b32 v83, 0x7ff, v83
  v_cvt_f32_u32 v80, v80
  v_cvt_f32_u32 v81, v81
  v_cvt_f32_u32 v82, v82
  v_cvt_f32_u32 v83, v83
  v_mul_f32 v80, s51, v80
  v_mul_f32 v81, s51, v81
  v_mul_f32 v82, s51, v82
  v_mul_f32 v83, s51, v83
  v_sin_f32 v84, v80
  v_sin_f32 v85, v81
  v_sin_f32 v86, v82
  v_sin_f32 v87, v83
  v_cos_f32 v80, v80
  v_cos_f32 v81, v81
  v_cos_f32 v82, v82
  v_cos_f32 v83, v83
  s_nop 0
  v_cvt_pk_bf16_f32 v160, v80, v84
  v_cvt_pk_bf16_f32 v161, v81, v85
  v_cvt_pk_bf16_f32 v162, v82, v86
  v_cvt_pk_bf16_f32 v163, v83, v87
  s_xor_b32 s50, s52, 2
  s_lshl_b32 s68, s50, 10
  s_and_b32 s65, s50, 1
  s_lshl_b32 s65, s65, 10
  s_lshr_b32 s50, s50, 1
  s_lshl_b32 s50, s50, 5
  s_add_u32 s50, s50, s65
  v_add_u32 v90, s50, v89
  v_add_u32 v80, 0, v88
  v_add_u32 v81, 1, v88
  v_add_u32 v82, 2, v88
  v_add_u32 v83, 3, v88
  v_mul_u32_u24 v80, v80, v90
  v_mul_u32_u24 v81, v81, v90
  v_mul_u32_u24 v82, v82, v90
  v_mul_u32_u24 v83, v83, v90
  v_and_b32 v80, 0x7ff, v80
  v_and_b32 v81, 0x7ff, v81
  v_and_b32 v82, 0x7ff, v82
  v_and_b32 v83, 0x7ff, v83
  v_cvt_f32_u32 v80, v80
  v_cvt_f32_u32 v81, v81
  v_cvt_f32_u32 v82, v82
  v_cvt_f32_u32 v83, v83
  v_mul_f32 v80, s51, v80
  v_mul_f32 v81, s51, v81
  v_mul_f32 v82, s51, v82
  v_mul_f32 v83, s51, v83
  v_sin_f32 v84, v80
  v_sin_f32 v85, v81
  v_sin_f32 v86, v82
  v_sin_f32 v87, v83
  v_cos_f32 v80, v80
  v_cos_f32 v81, v81
  v_cos_f32 v82, v82
  v_cos_f32 v83, v83
  s_nop 0
  v_cvt_pk_bf16_f32 v164, v80, v84
  v_cvt_pk_bf16_f32 v165, v81, v85
  v_cvt_pk_bf16_f32 v166, v82, v86
  v_cvt_pk_bf16_f32 v167, v83, v87
  s_xor_b32 s50, s52, 3
  s_lshl_b32 s69, s50, 10
  s_and_b32 s65, s50, 1
  s_lshl_b32 s65, s65, 10
  s_lshr_b32 s50, s50, 1
  s_lshl_b32 s50, s50, 5
  s_add_u32 s50, s50, s65
  v_add_u32 v90, s50, v89
  v_add_u32 v80, 0, v88
  v_add_u32 v81, 1, v88
  v_add_u32 v82, 2, v88
  v_add_u32 v83, 3, v88
  v_mul_u32_u24 v80, v80, v90
  v_mul_u32_u24 v81, v81, v90
  v_mul_u32_u24 v82, v82, v90
  v_mul_u32_u24 v83, v83, v90
  v_and_b32 v80, 0x7ff, v80
  v_and_b32 v81, 0x7ff, v81
  v_and_b32 v82, 0x7ff, v82
  v_and_b32 v83, 0x7ff, v83
  v_cvt_f32_u32 v80, v80
  v_cvt_f32_u32 v81, v81
  v_cvt_f32_u32 v82, v82
  v_cvt_f32_u32 v83, v83
  v_mul_f32 v80, s51, v80
  v_mul_f32 v81, s51, v81
  v_mul_f32 v82, s51, v82
  v_mul_f32 v83, s51, v83
  v_sin_f32 v84, v80
  v_sin_f32 v85, v81
  v_sin_f32 v86, v82
  v_sin_f32 v87, v83
  v_cos_f32 v80, v80
  v_cos_f32 v81, v81
  v_cos_f32 v82, v82
  v_cos_f32 v83, v83
  s_nop 0
  v_cvt_pk_bf16_f32 v168, v80, v84
  v_cvt_pk_bf16_f32 v169, v81, v85
  v_cvt_pk_bf16_f32 v170, v82, v86
  v_cvt_pk_bf16_f32 v171, v83, v87
  s_barrier
  s_add_u32 s65, s60, s66
  buffer_load_dwordx4 v[16:19], v6, s[32:35], s65 offen sc1
  s_add_u32 s65, s60, s67
  buffer_load_dwordx4 v[20:23], v6, s[32:35], s65 offen sc1
  s_add_u32 s65, s60, s68
  buffer_load_dwordx4 v[24:27], v6, s[32:35], s65 offen sc1
  s_add_u32 s65, s60, s69
  buffer_load_dwordx4 v[28:31], v6, s[32:35], s65 offen sc1
  s_add_u32 s60, s60, 4096
  s_add_u32 s65, s60, s66
  buffer_load_dwordx4 v[32:35], v6, s[32:35], s65 offen sc1
  s_add_u32 s65, s60, s67
  buffer_load_dwordx4 v[36:39], v6, s[32:35], s65 offen sc1
  s_add_u32 s65, s60, s68
  buffer_load_dwordx4 v[40:43], v6, s[32:35], s65 offen sc1
  s_add_u32 s65, s60, s69
  buffer_load_dwordx4 v[44:47], v6, s[32:35], s65 offen sc1
  s_add_u32 s60, s60, 4096
  s_add_u32 s65, s60, s66
  buffer_load_dwordx4 v[48:51], v6, s[32:35], s65 offen sc1
  s_add_u32 s65, s60, s67
  buffer_load_dwordx4 v[52:55], v6, s[32:35], s65 offen sc1
  s_add_u32 s65, s60, s68
  buffer_load_dwordx4 v[56:59], v6, s[32:35], s65 offen sc1
  s_add_u32 s65, s60, s69
  buffer_load_dwordx4 v[60:63], v6, s[32:35], s65 offen sc1
  s_add_u32 s60, s60, 4096
  s_add_u32 s65, s60, s66
  buffer_load_dwordx4 v[64:67], v6, s[32:35], s65 offen sc1
  s_add_u32 s65, s60, s67
  buffer_load_dwordx4 v[68:71], v6, s[32:35], s65 offen sc1
  s_add_u32 s65, s60, s68
  buffer_load_dwordx4 v[72:75], v6, s[32:35], s65 offen sc1
  s_add_u32 s65, s60, s69
  buffer_load_dwordx4 v[76:79], v6, s[32:35], s65 offen sc1
  s_add_u32 s60, s60, 4096
  buffer_load_dwordx4 v[80:83], v6, s[40:43], s61 offen offset:0 sc1
  buffer_load_dwordx4 v[84:87], v6, s[40:43], s61 offen offset:1024 sc1
  buffer_load_dwordx4 v[88:91], v6, s[40:43], s61 offen offset:2048 sc1
  buffer_load_dwordx4 v[92:95], v6, s[40:43], s61 offen offset:3072 sc1
  buffer_load_dwordx4 v[96:99], v7, s[40:43], s61 offen sc1
  s_add_u32 s61, s61, 5120
  buffer_load_dwordx4 v[100:103], v6, s[40:43], s61 offen offset:0 sc1
  buffer_load_dwordx4 v[104:107], v6, s[40:43], s61 offen offset:1024 sc1
  buffer_load_dwordx4 v[108:111], v6, s[40:43], s61 offen offset:2048 sc1
  buffer_load_dwordx4 v[112:115], v6, s[40:43], s61 offen offset:3072 sc1
  buffer_load_dwordx4 v[116:119], v7, s[40:43], s61 offen sc1
  s_add_u32 s61, s61, 5120
  ds_read_b128 v[140:143], v14 offset:0
  ds_read_b128 v[144:147], v14 offset:1024
  ds_read_b128 v[148:151], v14 offset:2048
  s_waitcnt vmcnt(22)
  s_waitcnt lgkmcnt(2)
  ds_read_b128 v[152:155], v14 offset:3072
  v_mfma_f32_16x16x32_bf16 v[176:179], v[140:143], v[16:19], 0
  v_mfma_f32_16x16x32_bf16 v[180:183], v[140:143], v[20:23], 0
  v_mfma_f32_16x16x32_bf16 v[184:187], v[140:143], v[24:27], 0
  v_mfma_f32_16x16x32_bf16 v[188:191], v[140:143], v[28:31], 0
  s_waitcnt lgkmcnt(2)
  ds_read_b128 v[140:143], v14 offset:4096
  v_mfma_f32_16x16x32_bf16 v[192:195], v[144:147], v[16:19], 0
  v_mfma_f32_16x16x32_bf16 v[196:199], v[144:147], v[20:23], 0
  v_mfma_f32_16x16x32_bf16 v[200:203], v[144:147], v[24:27], 0
  v_mfma_f32_16x16x32_bf16 v[204:207], v[144:147], v[28:31], 0
  s_waitcnt lgkmcnt(2)
  ds_read_b128 v[144:147], v14 offset:20480
  v_mfma_f32_16x16x32_bf16 v[208:211], v[148:151], v[16:19], 0
  v_mfma_f32_16x16x32_bf16 v[212:215], v[148:151], v[20:23], 0
  v_mfma_f32_16x16x32_bf16 v[216:219], v[148:151], v[24:27], 0
  v_mfma_f32_16x16x32_bf16 v[220:223], v[148:151], v[28:31], 0
  s_waitcnt lgkmcnt(2)
  ds_read_b128 v[148:151], v14 offset:21504
  v_mfma_f32_16x16x32_bf16 v[224:227], v[152:155], v[16:19], 0
  v_mfma_f32_16x16x32_bf16 v[228:231], v[152:155], v[20:23], 0
  v_mfma_f32_16x16x32_bf16 v[232:235], v[152:155], v[24:27], 0
  v_mfma_f32_16x16x32_bf16 v[236:239], v[152:155], v[28:31], 0
  s_waitcnt lgkmcnt(2)
  ds_read_b128 v[152:155], v14 offset:22528
  v_mfma_f32_16x16x32_bf16 v[240:243], v[140:143], v[16:19], 0
  v_mfma_f32_16x16x32_bf16 v[244:247], v[140:143], v[20:23], 0
  v_mfma_f32_16x16x32_bf16 v[248:251], v[140:143], v[24:27], 0
  v_mfma_f32_16x16x32_bf16 v[252:255], v[140:143], v[28:31], 0
  s_add_u32 s65, s60, s66
  buffer_load_dwordx4 v[16:19], v6, s[32:35], s65 offen sc1
  s_add_u32 s65, s60, s67
  buffer_load_dwordx4 v[20:23], v6, s[32:35], s65 offen sc1
  s_add_u32 s65, s60, s68
  buffer_load_dwordx4 v[24:27], v6, s[32:35], s65 offen sc1
  s_add_u32 s65, s60, s69
  buffer_load_dwordx4 v[28:31], v6, s[32:35], s65 offen sc1
  s_add_u32 s60, s60, 4096
  s_barrier
  buffer_load_dword v120, v8, s[36:39], s56 offen
  buffer_load_dword v121, v8, s[36:39], s57 offen
  buffer_load_dword v122, v8, s[36:39], s58 offen
  buffer_load_dword v123, v8, s[36:39], s59 offen
  buffer_load_dword v124, v9, s[36:39], s56 offen
  buffer_load_dword v125, v9, s[36:39], s57 offen
  buffer_load_dword v126, v9, s[36:39], s58 offen
  buffer_load_dword v127, v9, s[36:39], s59 offen
  buffer_load_dword v128, v10, s[36:39], s56 offen
  buffer_load_dword v129, v10, s[36:39], s57 offen
  buffer_load_dword v130, v10, s[36:39], s58 offen
  buffer_load_dword v131, v10, s[36:39], s59 offen
  buffer_load_dword v132, v11, s[36:39], s56 offen
  buffer_load_dword v133, v11, s[36:39], s57 offen
  buffer_load_dword v134, v11, s[36:39], s58 offen
  buffer_load_dword v135, v11, s[36:39], s59 offen
  buffer_load_dword v136, v12, s[36:39], s56 offen
  buffer_load_dword v137, v12, s[36:39], s57 offen
  buffer_load_dword v138, v12, s[36:39], s58 offen
  buffer_load_dword v139, v12, s[36:39], s59 offen
  s_waitcnt vmcnt(42)
  s_waitcnt lgkmcnt(2)
  ds_read_b128 v[140:143], v14 offset:23552
  v_mfma_f32_16x16x32_bf16 v[176:179], v[144:147], v[32:35], v[176:179]
  v_mfma_f32_16x16x32_bf16 v[180:183], v[144:147], v[36:39], v[180:183]
  v_mfma_f32_16x16x32_bf16 v[184:187], v[144:147], v[40:43], v[184:187]
  v_mfma_f32_16x16x32_bf16 v[188:191], v[144:147], v[44:47], v[188:191]
  s_waitcnt lgkmcnt(2)
  ds_read_b128 v[144:147], v14 offset:24576
  v_mfma_f32_16x16x32_bf16 v[192:195], v[148:151], v[32:35], v[192:195]
  v_mfma_f32_16x16x32_bf16 v[196:199], v[148:151], v[36:39], v[196:199]
  v_mfma_f32_16x16x32_bf16 v[200:203], v[148:151], v[40:43], v[200:203]
  v_mfma_f32_16x16x32_bf16 v[204:207], v[148:151], v[44:47], v[204:207]
  s_waitcnt lgkmcnt(2)
  ds_read_b128 v[148:151], v14 offset:40960
  v_mfma_f32_16x16x32_bf16 v[208:211], v[152:155], v[32:35], v[208:211]
  v_mfma_f32_16x16x32_bf16 v[212:215], v[152:155], v[36:39], v[212:215]
  v_mfma_f32_16x16x32_bf16 v[216:219], v[152:155], v[40:43], v[216:219]
  v_mfma_f32_16x16x32_bf16 v[220:223], v[152:155], v[44:47], v[220:223]
  s_waitcnt lgkmcnt(2)
  ds_read_b128 v[152:155], v14 offset:41984
  v_mfma_f32_16x16x32_bf16 v[224:227], v[140:143], v[32:35], v[224:227]
  v_mfma_f32_16x16x32_bf16 v[228:231], v[140:143], v[36:39], v[228:231]
  v_mfma_f32_16x16x32_bf16 v[232:235], v[140:143], v[40:43], v[232:235]
  v_mfma_f32_16x16x32_bf16 v[236:239], v[140:143], v[44:47], v[236:239]
  s_waitcnt lgkmcnt(2)
  ds_read_b128 v[140:143], v14 offset:43008
  v_mfma_f32_16x16x32_bf16 v[240:243], v[144:147], v[32:35], v[240:243]
  v_mfma_f32_16x16x32_bf16 v[244:247], v[144:147], v[36:39], v[244:247]
  v_mfma_f32_16x16x32_bf16 v[248:251], v[144:147], v[40:43], v[248:251]
  v_mfma_f32_16x16x32_bf16 v[252:255], v[144:147], v[44:47], v[252:255]
  s_add_u32 s65, s60, s66
  buffer_load_dwordx4 v[32:35], v6, s[32:35], s65 offen sc1
  s_add_u32 s65, s60, s67
  buffer_load_dwordx4 v[36:39], v6, s[32:35], s65 offen sc1
  s_add_u32 s65, s60, s68
  buffer_load_dwordx4 v[40:43], v6, s[32:35], s65 offen sc1
  s_add_u32 s65, s60, s69
  buffer_load_dwordx4 v[44:47], v6, s[32:35], s65 offen sc1
  s_add_u32 s60, s60, 4096
  s_waitcnt vmcnt(42)
  s_waitcnt lgkmcnt(2)
  ds_read_b128 v[144:147], v14 offset:44032
  v_mfma_f32_16x16x32_bf16 v[176:179], v[148:151], v[48:51], v[176:179]
  v_mfma_f32_16x16x32_bf16 v[180:183], v[148:151], v[52:55], v[180:183]
  v_mfma_f32_16x16x32_bf16 v[184:187], v[148:151], v[56:59], v[184:187]
  v_mfma_f32_16x16x32_bf16 v[188:191], v[148:151], v[60:63], v[188:191]
  s_waitcnt lgkmcnt(2)
  ds_read_b128 v[148:151], v14 offset:45056
  v_mfma_f32_16x16x32_bf16 v[192:195], v[152:155], v[48:51], v[192:195]
  v_mfma_f32_16x16x32_bf16 v[196:199], v[152:155], v[52:55], v[196:199]
  v_mfma_f32_16x16x32_bf16 v[200:203], v[152:155], v[56:59], v[200:203]
  v_mfma_f32_16x16x32_bf16 v[204:207], v[152:155], v[60:63], v[204:207]
  s_waitcnt lgkmcnt(2)
  ds_read_b128 v[152:155], v15 offset:0
  v_mfma_f32_16x16x32_bf16 v[208:211], v[140:143], v[48:51], v[208:211]
  v_mfma_f32_16x16x32_bf16 v[212:215], v[140:143], v[52:55], v[212:215]
  v_mfma_f32_16x16x32_bf16 v[216:219], v[140:143], v[56:59], v[216:219]
  v_mfma_f32_16x16x32_bf16 v[220:223], v[140:143], v[60:63], v[220:223]
  s_waitcnt lgkmcnt(2)
  ds_read_b128 v[140:143], v15 offset:1024
  v_mfma_f32_16x16x32_bf16 v[224:227], v[144:147], v[48:51], v[224:227]
  v_mfma_f32_16x16x32_bf16 v[228:231], v[144:147], v[52:55], v[228:231]
  v_mfma_f32_16x16x32_bf16 v[232:235], v[144:147], v[56:59], v[232:235]
  v_mfma_f32_16x16x32_bf16 v[236:239], v[144:147], v[60:63], v[236:239]
  s_waitcnt lgkmcnt(2)
  ds_read_b128 v[144:147], v15 offset:2048
  v_mfma_f32_16x16x32_bf16 v[240:243], v[148:151], v[48:51], v[240:243]
  v_mfma_f32_16x16x32_bf16 v[244:247], v[148:151], v[52:55], v[244:247]
  v_mfma_f32_16x16x32_bf16 v[248:251], v[148:151], v[56:59], v[248:251]
  v_mfma_f32_16x16x32_bf16 v[252:255], v[148:151], v[60:63], v[252:255]
  s_add_u32 s65, s60, s66
  buffer_load_dwordx4 v[48:51], v6, s[32:35], s65 offen sc1
  s_add_u32 s65, s60, s67
  buffer_load_dwordx4 v[52:55], v6, s[32:35], s65 offen sc1
  s_add_u32 s65, s60, s68
  buffer_load_dwordx4 v[56:59], v6, s[32:35], s65 offen sc1
  s_add_u32 s65, s60, s69
  buffer_load_dwordx4 v[60:63], v6, s[32:35], s65 offen sc1
  s_add_u32 s60, s60, 4096
  s_waitcnt vmcnt(42)
  s_waitcnt lgkmcnt(2)
  ds_read_b128 v[148:151], v15 offset:3072
  v_mfma_f32_16x16x32_bf16 v[176:179], v[152:155], v[64:67], v[176:179]
  v_mfma_f32_16x16x32_bf16 v[180:183], v[152:155], v[68:71], v[180:183]
  v_mfma_f32_16x16x32_bf16 v[184:187], v[152:155], v[72:75], v[184:187]
  v_mfma_f32_16x16x32_bf16 v[188:191], v[152:155], v[76:79], v[188:191]
  s_waitcnt lgkmcnt(2)
  ds_read_b128 v[152:155], v15 offset:4096
  v_mfma_f32_16x16x32_bf16 v[192:195], v[140:143], v[64:67], v[192:195]
  v_mfma_f32_16x16x32_bf16 v[196:199], v[140:143], v[68:71], v[196:199]
  v_mfma_f32_16x16x32_bf16 v[200:203], v[140:143], v[72:75], v[200:203]
  v_mfma_f32_16x16x32_bf16 v[204:207], v[140:143], v[76:79], v[204:207]
  s_waitcnt lgkmcnt(2)
  ds_read_b128 v[140:143], v15 offset:20480
  v_mfma_f32_16x16x32_bf16 v[208:211], v[144:147], v[64:67], v[208:211]
  v_mfma_f32_16x16x32_bf16 v[212:215], v[144:147], v[68:71], v[212:215]
  v_mfma_f32_16x16x32_bf16 v[216:219], v[144:147], v[72:75], v[216:219]
  v_mfma_f32_16x16x32_bf16 v[220:223], v[144:147], v[76:79], v[220:223]
  s_waitcnt lgkmcnt(2)
  ds_read_b128 v[144:147], v15 offset:21504
  v_mfma_f32_16x16x32_bf16 v[224:227], v[148:151], v[64:67], v[224:227]
  v_mfma_f32_16x16x32_bf16 v[228:231], v[148:151], v[68:71], v[228:231]
  v_mfma_f32_16x16x32_bf16 v[232:235], v[148:151], v[72:75], v[232:235]
  v_mfma_f32_16x16x32_bf16 v[236:239], v[148:151], v[76:79], v[236:239]
  s_waitcnt lgkmcnt(2)
  ds_read_b128 v[148:151], v15 offset:22528
  v_mfma_f32_16x16x32_bf16 v[240:243], v[152:155], v[64:67], v[240:243]
  v_mfma_f32_16x16x32_bf16 v[244:247], v[152:155], v[68:71], v[244:247]
  v_mfma_f32_16x16x32_bf16 v[248:251], v[152:155], v[72:75], v[248:251]
  v_mfma_f32_16x16x32_bf16 v[252:255], v[152:155], v[76:79], v[252:255]
  s_add_u32 s65, s60, s66
  buffer_load_dwordx4 v[64:67], v6, s[32:35], s65 offen sc1
  s_add_u32 s65, s60, s67
  buffer_load_dwordx4 v[68:71], v6, s[32:35], s65 offen sc1
  s_add_u32 s65, s60, s68
  buffer_load_dwordx4 v[72:75], v6, s[32:35], s65 offen sc1
  s_add_u32 s65, s60, s69
  buffer_load_dwordx4 v[76:79], v6, s[32:35], s65 offen sc1
  s_add_u32 s60, s60, 4096
  s_waitcnt vmcnt(32)
  s_waitcnt lgkmcnt(2)
  ds_read_b128 v[152:155], v15 offset:23552
  v_mfma_f32_16x16x32_bf16 v[176:179], v[140:143], v[16:19], v[176:179]
  v_mfma_f32_16x16x32_bf16 v[180:183], v[140:143], v[20:23], v[180:183]
  v_mfma_f32_16x16x32_bf16 v[184:187], v[140:143], v[24:27], v[184:187]
  v_mfma_f32_16x16x32_bf16 v[188:191], v[140:143], v[28:31], v[188:191]
  s_waitcnt lgkmcnt(2)
  ds_read_b128 v[140:143], v15 offset:24576
  v_mfma_f32_16x16x32_bf16 v[192:195], v[144:147], v[16:19], v[192:195]
  v_mfma_f32_16x16x32_bf16 v[196:199], v[144:147], v[20:23], v[196:199]
  v_mfma_f32_16x16x32_bf16 v[200:203], v[144:147], v[24:27], v[200:203]
  v_mfma_f32_16x16x32_bf16 v[204:207], v[144:147], v[28:31], v[204:207]
  s_waitcnt lgkmcnt(2)
  ds_read_b128 v[144:147], v15 offset:40960
  v_mfma_f32_16x16x32_bf16 v[208:211], v[148:151], v[16:19], v[208:211]
  v_mfma_f32_16x16x32_bf16 v[212:215], v[148:151], v[20:23], v[212:215]
  v_mfma_f32_16x16x32_bf16 v[216:219], v[148:151], v[24:27], v[216:219]
  v_mfma_f32_16x16x32_bf16 v[220:223], v[148:151], v[28:31], v[220:223]
  s_waitcnt lgkmcnt(2)
  ds_read_b128 v[148:151], v15 offset:41984
  v_mfma_f32_16x16x32_bf16 v[224:227], v[152:155], v[16:19], v[224:227]
  v_mfma_f32_16x16x32_bf16 v[228:231], v[152:155], v[20:23], v[228:231]
  v_mfma_f32_16x16x32_bf16 v[232:235], v[152:155], v[24:27], v[232:235]
  v_mfma_f32_16x16x32_bf16 v[236:239], v[152:155], v[28:31], v[236:239]
  s_waitcnt lgkmcnt(2)
  ds_read_b128 v[152:155], v15 offset:43008
  v_mfma_f32_16x16x32_bf16 v[240:243], v[140:143], v[16:19], v[240:243]
  v_mfma_f32_16x16x32_bf16 v[244:247], v[140:143], v[20:23], v[244:247]
  v_mfma_f32_16x16x32_bf16 v[248:251], v[140:143], v[24:27], v[248:251]
  v_mfma_f32_16x16x32_bf16 v[252:255], v[140:143], v[28:31], v[252:255]
  s_add_u32 s65, s60, s66
  buffer_load_dwordx4 v[16:19], v6, s[32:35], s65 offen sc1
  s_add_u32 s65, s60, s67
  buffer_load_dwordx4 v[20:23], v6, s[32:35], s65 offen sc1
  s_add_u32 s65, s60, s68
  buffer_load_dwordx4 v[24:27], v6, s[32:35], s65 offen sc1
  s_add_u32 s65, s60, s69
  buffer_load_dwordx4 v[28:31], v6, s[32:35], s65 offen sc1
  s_add_u32 s60, s60, 4096
  s_waitcnt vmcnt(12)
  s_waitcnt lgkmcnt(2)
  ds_read_b128 v[140:143], v15 offset:44032
  v_mfma_f32_16x16x32_bf16 v[176:179], v[144:147], v[32:35], v[176:179]
  v_mfma_f32_16x16x32_bf16 v[180:183], v[144:147], v[36:39], v[180:183]
  v_mfma_f32_16x16x32_bf16 v[184:187], v[144:147], v[40:43], v[184:187]
  v_mfma_f32_16x16x32_bf16 v[188:191], v[144:147], v[44:47], v[188:191]
  s_waitcnt lgkmcnt(2)
  ds_read_b128 v[144:147], v15 offset:45056
  v_mfma_f32_16x16x32_bf16 v[192:195], v[148:151], v[32:35], v[192:195]
  v_mfma_f32_16x16x32_bf16 v[196:199], v[148:151], v[36:39], v[196:199]
  v_mfma_f32_16x16x32_bf16 v[200:203], v[148:151], v[40:43], v[200:203]
  v_mfma_f32_16x16x32_bf16 v[204:207], v[148:151], v[44:47], v[204:207]
  s_waitcnt lgkmcnt(2)
  ds_read_b128 v[148:151], v172 offset:0
  v_mfma_f32_16x16x32_bf16 v[208:211], v[152:155], v[32:35], v[208:211]
  v_mfma_f32_16x16x32_bf16 v[212:215], v[152:155], v[36:39], v[212:215]
  v_mfma_f32_16x16x32_bf16 v[216:219], v[152:155], v[40:43], v[216:219]
  v_mfma_f32_16x16x32_bf16 v[220:223], v[152:155], v[44:47], v[220:223]
  s_waitcnt lgkmcnt(2)
  ds_read_b128 v[152:155], v172 offset:1024
  v_mfma_f32_16x16x32_bf16 v[224:227], v[140:143], v[32:35], v[224:227]
  v_mfma_f32_16x16x32_bf16 v[228:231], v[140:143], v[36:39], v[228:231]
  v_mfma_f32_16x16x32_bf16 v[232:235], v[140:143], v[40:43], v[232:235]
  v_mfma_f32_16x16x32_bf16 v[236:239], v[140:143], v[44:47], v[236:239]
  s_waitcnt lgkmcnt(2)
  ds_read_b128 v[140:143], v172 offset:2048
  v_mfma_f32_16x16x32_bf16 v[240:243], v[144:147], v[32:35], v[240:243]
  v_mfma_f32_16x16x32_bf16 v[244:247], v[144:147], v[36:39], v[244:247]
  v_mfma_f32_16x16x32_bf16 v[248:251], v[144:147], v[40:43], v[248:251]
  v_mfma_f32_16x16x32_bf16 v[252:255], v[144:147], v[44:47], v[252:255]
  s_waitcnt vmcnt(16)
  v_mfma_f32_16x16x32_bf16 v[176:179], v[120:123], v[156:159], v[176:179]
  v_mfma_f32_16x16x32_bf16 v[180:183], v[120:123], v[160:163], v[180:183]
  v_mfma_f32_16x16x32_bf16 v[184:187], v[120:123], v[164:167], v[184:187]
  v_mfma_f32_16x16x32_bf16 v[188:191], v[120:123], v[168:171], v[188:191]
  v_mfma_f32_16x16x32_bf16 v[192:195], v[124:127], v[156:159], v[192:195]
  v_mfma_f32_16x16x32_bf16 v[196:199], v[124:127], v[160:163], v[196:199]
  v_mfma_f32_16x16x32_bf16 v[200:203], v[124:127], v[164:167], v[200:203]
  v_mfma_f32_16x16x32_bf16 v[204:207], v[124:127], v[168:171], v[204:207]
  v_mfma_f32_16x16x32_bf16 v[208:211], v[128:131], v[156:159], v[208:211]
  v_mfma_f32_16x16x32_bf16 v[212:215], v[128:131], v[160:163], v[212:215]
  v_mfma_f32_16x16x32_bf16 v[216:219], v[128:131], v[164:167], v[216:219]
  v_mfma_f32_16x16x32_bf16 v[220:223], v[128:131], v[168:171], v[220:223]
  v_mfma_f32_16x16x32_bf16 v[224:227], v[132:135], v[156:159], v[224:227]
  v_mfma_f32_16x16x32_bf16 v[228:231], v[132:135], v[160:163], v[228:231]
  v_mfma_f32_16x16x32_bf16 v[232:235], v[132:135], v[164:167], v[232:235]
  v_mfma_f32_16x16x32_bf16 v[236:239], v[132:135], v[168:171], v[236:239]
  v_mfma_f32_16x16x32_bf16 v[240:243], v[136:139], v[156:159], v[240:243]
  v_mfma_f32_16x16x32_bf16 v[244:247], v[136:139], v[160:163], v[244:247]
  v_mfma_f32_16x16x32_bf16 v[248:251], v[136:139], v[164:167], v[248:251]
  v_mfma_f32_16x16x32_bf16 v[252:255], v[136:139], v[168:171], v[252:255]
  s_add_u32 s65, s60, s66
  buffer_load_dwordx4 v[32:35], v6, s[32:35], s65 offen sc1
  s_add_u32 s65, s60, s67
  buffer_load_dwordx4 v[36:39], v6, s[32:35], s65 offen sc1
  s_add_u32 s65, s60, s68
  buffer_load_dwordx4 v[40:43], v6, s[32:35], s65 offen sc1
  s_add_u32 s65, s60, s69
  buffer_load_dwordx4 v[44:47], v6, s[32:35], s65 offen sc1
  s_add_u32 s60, s60, 4096
  buffer_load_dwordx4 v[120:123], v6, s[40:43], s61 offen offset:0 sc1
  buffer_load_dwordx4 v[124:127], v6, s[40:43], s61 offen offset:1024 sc1
  buffer_load_dwordx4 v[128:131], v6, s[40:43], s61 offen offset:2048 sc1
  buffer_load_dwordx4 v[132:135], v6, s[40:43], s61 offen offset:3072 sc1
  buffer_load_dwordx4 v[136:139], v7, s[40:43], s61 offen sc1
  s_add_u32 s61, s61, 5120
  s_waitcnt vmcnt(17)
  s_waitcnt lgkmcnt(2)
  ds_read_b128 v[144:147], v172 offset:3072
  v_mfma_f32_16x16x32_bf16 v[176:179], v[148:151], v[48:51], v[176:179]
  v_mfma_f32_16x16x32_bf16 v[180:183], v[148:151], v[52:55], v[180:183]
  v_mfma_f32_16x16x32_bf16 v[184:187], v[148:151], v[56:59], v[184:187]
  v_mfma_f32_16x16x32_bf16 v[188:191], v[148:151], v[60:63], v[188:191]
  s_waitcnt lgkmcnt(2)
  ds_read_b128 v[148:151], v172 offset:4096
  v_mfma_f32_16x16x32_bf16 v[192:195], v[152:155], v[48:51], v[192:195]
  v_mfma_f32_16x16x32_bf16 v[196:199], v[152:155], v[52:55], v[196:199]
  v_mfma_f32_16x16x32_bf16 v[200:203], v[152:155], v[56:59], v[200:203]
  v_mfma_f32_16x16x32_bf16 v[204:207], v[152:155], v[60:63], v[204:207]
  s_waitcnt lgkmcnt(2)
  ds_read_b128 v[152:155], v172 offset:20480
  v_mfma_f32_16x16x32_bf16 v[208:211], v[140:143], v[48:51], v[208:211]
  v_mfma_f32_16x16x32_bf16 v[212:215], v[140:143], v[52:55], v[212:215]
  v_mfma_f32_16x16x32_bf16 v[216:219], v[140:143], v[56:59], v[216:219]
  v_mfma_f32_16x16x32_bf16 v[220:223], v[140:143], v[60:63], v[220:223]
  s_waitcnt lgkmcnt(2)
  ds_read_b128 v[140:143], v172 offset:21504
  v_mfma_f32_16x16x32_bf16 v[224:227], v[144:147], v[48:51], v[224:227]
  v_mfma_f32_16x16x32_bf16 v[228:231], v[144:147], v[52:55], v[228:231]
  v_mfma_f32_16x16x32_bf16 v[232:235], v[144:147], v[56:59], v[232:235]
  v_mfma_f32_16x16x32_bf16 v[236:239], v[144:147], v[60:63], v[236:239]
  s_waitcnt lgkmcnt(2)
  ds_read_b128 v[144:147], v172 offset:22528
  v_mfma_f32_16x16x32_bf16 v[240:243], v[148:151], v[48:51], v[240:243]
  v_mfma_f32_16x16x32_bf16 v[244:247], v[148:151], v[52:55], v[244:247]
  v_mfma_f32_16x16x32_bf16 v[248:251], v[148:151], v[56:59], v[248:251]
  v_mfma_f32_16x16x32_bf16 v[252:255], v[148:151], v[60:63], v[252:255]
  s_add_u32 s65, s60, s66
  buffer_load_dwordx4 v[48:51], v6, s[32:35], s65 offen sc1
  s_add_u32 s65, s60, s67
  buffer_load_dwordx4 v[52:55], v6, s[32:35], s65 offen sc1
  s_add_u32 s65, s60, s68
  buffer_load_dwordx4 v[56:59], v6, s[32:35], s65 offen sc1
  s_add_u32 s65, s60, s69
  buffer_load_dwordx4 v[60:63], v6, s[32:35], s65 offen sc1
  s_add_u32 s60, s60, 4096
  s_waitcnt vmcnt(17)
  s_waitcnt lgkmcnt(2)
  ds_read_b128 v[148:151], v172 offset:23552
  v_mfma_f32_16x16x32_bf16 v[176:179], v[152:155], v[64:67], v[176:179]
  v_mfma_f32_16x16x32_bf16 v[180:183], v[152:155], v[68:71], v[180:183]
  v_mfma_f32_16x16x32_bf16 v[184:187], v[152:155], v[72:75], v[184:187]
  v_mfma_f32_16x16x32_bf16 v[188:191], v[152:155], v[76:79], v[188:191]
  s_waitcnt lgkmcnt(2)
  ds_read_b128 v[152:155], v172 offset:24576
  v_mfma_f32_16x16x32_bf16 v[192:195], v[140:143], v[64:67], v[192:195]
  v_mfma_f32_16x16x32_bf16 v[196:199], v[140:143], v[68:71], v[196:199]
  v_mfma_f32_16x16x32_bf16 v[200:203], v[140:143], v[72:75], v[200:203]
  v_mfma_f32_16x16x32_bf16 v[204:207], v[140:143], v[76:79], v[204:207]
  s_waitcnt lgkmcnt(2)
  v_mfma_f32_16x16x32_bf16 v[208:211], v[144:147], v[64:67], v[208:211]
  v_mfma_f32_16x16x32_bf16 v[212:215], v[144:147], v[68:71], v[212:215]
  v_mfma_f32_16x16x32_bf16 v[216:219], v[144:147], v[72:75], v[216:219]
  v_mfma_f32_16x16x32_bf16 v[220:223], v[144:147], v[76:79], v[220:223]
  s_waitcnt lgkmcnt(1)
  v_mfma_f32_16x16x32_bf16 v[224:227], v[148:151], v[64:67], v[224:227]
  v_mfma_f32_16x16x32_bf16 v[228:231], v[148:151], v[68:71], v[228:231]
  v_mfma_f32_16x16x32_bf16 v[232:235], v[148:151], v[72:75], v[232:235]
  v_mfma_f32_16x16x32_bf16 v[236:239], v[148:151], v[76:79], v[236:239]
  s_waitcnt lgkmcnt(0)
  v_mfma_f32_16x16x32_bf16 v[240:243], v[152:155], v[64:67], v[240:243]
  v_mfma_f32_16x16x32_bf16 v[244:247], v[152:155], v[68:71], v[244:247]
  v_mfma_f32_16x16x32_bf16 v[248:251], v[152:155], v[72:75], v[248:251]
  v_mfma_f32_16x16x32_bf16 v[252:255], v[152:155], v[76:79], v[252:255]
  s_add_u32 s65, s60, s66
  buffer_load_dwordx4 v[64:67], v6, s[32:35], s65 offen sc1
  s_add_u32 s65, s60, s67
  buffer_load_dwordx4 v[68:71], v6, s[32:35], s65 offen sc1
  s_add_u32 s65, s60, s68
  buffer_load_dwordx4 v[72:75], v6, s[32:35], s65 offen sc1
  s_add_u32 s65, s60, s69
  buffer_load_dwordx4 v[76:79], v6, s[32:35], s65 offen sc1
  s_add_u32 s60, s60, 4096
  s_waitcnt vmcnt(17)
  v_mfma_f32_16x16x32_bf16 v[176:179], v[80:83], v[16:19], v[176:179]
  v_mfma_f32_16x16x32_bf16 v[180:183], v[80:83], v[20:23], v[180:183]
  v_mfma_f32_16x16x32_bf16 v[184:187], v[80:83], v[24:27], v[184:187]
  v_mfma_f32_16x16x32_bf16 v[188:191], v[80:83], v[28:31], v[188:191]
  v_mfma_f32_16x16x32_bf16 v[192:195], v[84:87], v[16:19], v[192:195]
  v_mfma_f32_16x16x32_bf16 v[196:199], v[84:87], v[20:23], v[196:199]
  v_mfma_f32_16x16x32_bf16 v[200:203], v[84:87], v[24:27], v[200:203]
  v_mfma_f32_16x16x32_bf16 v[204:207], v[84:87], v[28:31], v[204:207]
  v_mfma_f32_16x16x32_bf16 v[208:211], v[88:91], v[16:19], v[208:211]
  v_mfma_f32_16x16x32_bf16 v[212:215], v[88:91], v[20:23], v[212:215]
  v_mfma_f32_16x16x32_bf16 v[216:219], v[88:91], v[24:27], v[216:219]
  v_mfma_f32_16x16x32_bf16 v[220:223], v[88:91], v[28:31], v[220:223]
  v_mfma_f32_16x16x32_bf16 v[224:227], v[92:95], v[16:19], v[224:227]
  v_mfma_f32_16x16x32_bf16 v[228:231], v[92:95], v[20:23], v[228:231]
  v_mfma_f32_16x16x32_bf16 v[232:235], v[92:95], v[24:27], v[232:235]
  v_mfma_f32_16x16x32_bf16 v[236:239], v[92:95], v[28:31], v[236:239]
  v_mfma_f32_16x16x32_bf16 v[240:243], v[96:99], v[16:19], v[240:243]
  v_mfma_f32_16x16x32_bf16 v[244:247], v[96:99], v[20:23], v[244:247]
  v_mfma_f32_16x16x32_bf16 v[248:251], v[96:99], v[24:27], v[248:251]
  v_mfma_f32_16x16x32_bf16 v[252:255], v[96:99], v[28:31], v[252:255]
  s_add_u32 s65, s60, s66
  buffer_load_dwordx4 v[16:19], v6, s[32:35], s65 offen sc1
  s_add_u32 s65, s60, s67
  buffer_load_dwordx4 v[20:23], v6, s[32:35], s65 offen sc1
  s_add_u32 s65, s60, s68
  buffer_load_dwordx4 v[24:27], v6, s[32:35], s65 offen sc1
  s_add_u32 s65, s60, s69
  buffer_load_dwordx4 v[28:31], v6, s[32:35], s65 offen sc1
  s_add_u32 s60, s60, 4096
  s_cmp_ge_u32 s52, 2
  s_cselect_b32 s60, 2147418112, s60
  buffer_load_dwordx4 v[80:83], v6, s[40:43], s61 offen offset:0 sc1
  buffer_load_dwordx4 v[84:87], v6, s[40:43], s61 offen offset:1024 sc1
  buffer_load_dwordx4 v[88:91], v6, s[40:43], s61 offen offset:2048 sc1
  buffer_load_dwordx4 v[92:95], v6, s[40:43], s61 offen offset:3072 sc1
  buffer_load_dwordx4 v[96:99], v7, s[40:43], s61 offen sc1
  s_add_u32 s61, s61, 5120
  s_barrier
  s_waitcnt vmcnt(22)
  v_mfma_f32_16x16x32_bf16 v[176:179], v[100:103], v[32:35], v[176:179]
  v_mfma_f32_16x16x32_bf16 v[180:183], v[100:103], v[36:39], v[180:183]
  v_mfma_f32_16x16x32_bf16 v[184:187], v[100:103], v[40:43], v[184:187]
  v_mfma_f32_16x16x32_bf16 v[188:191], v[100:103], v[44:47], v[188:191]
  v_mfma_f32_16x16x32_bf16 v[192:195], v[104:107], v[32:35], v[192:195]
  v_mfma_f32_16x16x32_bf16 v[196:199], v[104:107], v[36:39], v[196:199]
  v_mfma_f32_16x16x32_bf16 v[200:203], v[104:107], v[40:43], v[200:203]
  v_mfma_f32_16x16x32_bf16 v[204:207], v[104:107], v[44:47], v[204:207]
  v_mfma_f32_16x16x32_bf16 v[208:211], v[108:111], v[32:35], v[208:211]
  v_mfma_f32_16x16x32_bf16 v[212:215], v[108:111], v[36:39], v[212:215]
  v_mfma_f32_16x16x32_bf16 v[216:219], v[108:111], v[40:43], v[216:219]
  v_mfma_f32_16x16x32_bf16 v[220:223], v[108:111], v[44:47], v[220:223]
  v_mfma_f32_16x16x32_bf16 v[224:227], v[112:115], v[32:35], v[224:227]
  v_mfma_f32_16x16x32_bf16 v[228:231], v[112:115], v[36:39], v[228:231]
  v_mfma_f32_16x16x32_bf16 v[232:235], v[112:115], v[40:43], v[232:235]
  v_mfma_f32_16x16x32_bf16 v[236:239], v[112:115], v[44:47], v[236:239]
  v_mfma_f32_16x16x32_bf16 v[240:243], v[116:119], v[32:35], v[240:243]
  v_mfma_f32_16x16x32_bf16 v[244:247], v[116:119], v[36:39], v[244:247]
  v_mfma_f32_16x16x32_bf16 v[248:251], v[116:119], v[40:43], v[248:251]
  v_mfma_f32_16x16x32_bf16 v[252:255], v[116:119], v[44:47], v[252:255]
  s_add_u32 s65, s60, s66
  buffer_load_dwordx4 v[32:35], v6, s[32:35], s65 offen sc1
  s_add_u32 s65, s60, s67
  buffer_load_dwordx4 v[36:39], v6, s[32:35], s65 offen sc1
  s_add_u32 s65, s60, s68
  buffer_load_dwordx4 v[40:43], v6, s[32:35], s65 offen sc1
  s_add_u32 s65, s60, s69
  buffer_load_dwordx4 v[44:47], v6, s[32:35], s65 offen sc1
  s_add_u32 s60, s60, 4096
  buffer_load_dwordx4 v[100:103], v6, s[40:43], s61 offen offset:0 sc1
  buffer_load_dwordx4 v[104:107], v6, s[40:43], s61 offen offset:1024 sc1
  buffer_load_dwordx4 v[108:111], v6, s[40:43], s61 offen offset:2048 sc1
  buffer_load_dwordx4 v[112:115], v6, s[40:43], s61 offen offset:3072 sc1
  buffer_load_dwordx4 v[116:119], v7, s[40:43], s61 offen sc1
  s_add_u32 s61, s61, 5120
  s_cmp_ge_u32 s52, 2
  s_cselect_b32 s61, 2147418112, s61
  s_waitcnt vmcnt(22)
  v_mfma_f32_16x16x32_bf16 v[176:179], v[120:123], v[48:51], v[176:179]
  v_mfma_f32_16x16x32_bf16 v[180:183], v[120:123], v[52:55], v[180:183]
  v_mfma_f32_16x16x32_bf16 v[184:187], v[120:123], v[56:59], v[184:187]
  v_mfma_f32_16x16x32_bf16 v[188:191], v[120:123], v[60:63], v[188:191]
  v_mfma_f32_16x16x32_bf16 v[192:195], v[124:127], v[48:51], v[192:195]
  v_mfma_f32_16x16x32_bf16 v[196:199], v[124:127], v[52:55], v[196:199]
  v_mfma_f32_16x16x32_bf16 v[200:203], v[124:127], v[56:59], v[200:203]
  v_mfma_f32_16x16x32_bf16 v[204:207], v[124:127], v[60:63], v[204:207]
  v_mfma_f32_16x16x32_bf16 v[208:211], v[128:131], v[48:51], v[208:211]
  v_mfma_f32_16x16x32_bf16 v[212:215], v[128:131], v[52:55], v[212:215]
  v_mfma_f32_16x16x32_bf16 v[216:219], v[128:131], v[56:59], v[216:219]
  v_mfma_f32_16x16x32_bf16 v[220:223], v[128:131], v[60:63], v[220:223]
  v_mfma_f32_16x16x32_bf16 v[224:227], v[132:135], v[48:51], v[224:227]
  v_mfma_f32_16x16x32_bf16 v[228:231], v[132:135], v[52:55], v[228:231]
  v_mfma_f32_16x16x32_bf16 v[232:235], v[132:135], v[56:59], v[232:235]
  v_mfma_f32_16x16x32_bf16 v[236:239], v[132:135], v[60:63], v[236:239]
  v_mfma_f32_16x16x32_bf16 v[240:243], v[136:139], v[48:51], v[240:243]
  v_mfma_f32_16x16x32_bf16 v[244:247], v[136:139], v[52:55], v[244:247]
  v_mfma_f32_16x16x32_bf16 v[248:251], v[136:139], v[56:59], v[248:251]
  v_mfma_f32_16x16x32_bf16 v[252:255], v[136:139], v[60:63], v[252:255]
  buffer_load_dwordx4 v[120:123], v6, s[40:43], s61 offen offset:0 sc1
  buffer_load_dwordx4 v[124:127], v6, s[40:43], s61 offen offset:1024 sc1
  buffer_load_dwordx4 v[128:131], v6, s[40:43], s61 offen offset:2048 sc1
  buffer_load_dwordx4 v[132:135], v6, s[40:43], s61 offen offset:3072 sc1
  buffer_load_dwordx4 v[136:139], v7, s[40:43], s61 offen sc1
  s_add_u32 s61, s61, 5120
  s_waitcnt vmcnt(14)
  v_mfma_f32_16x16x32_bf16 v[176:179], v[80:83], v[64:67], v[176:179]
  v_mfma_f32_16x16x32_bf16 v[180:183], v[80:83], v[68:71], v[180:183]
  v_mfma_f32_16x16x32_bf16 v[184:187], v[80:83], v[72:75], v[184:187]
  v_mfma_f32_16x16x32_bf16 v[188:191], v[80:83], v[76:79], v[188:191]
  v_mfma_f32_16x16x32_bf16 v[192:195], v[84:87], v[64:67], v[192:195]
  v_mfma_f32_16x16x32_bf16 v[196:199], v[84:87], v[68:71], v[196:199]
  v_mfma_f32_16x16x32_bf16 v[200:203], v[84:87], v[72:75], v[200:203]
  v_mfma_f32_16x16x32_bf16 v[204:207], v[84:87], v[76:79], v[204:207]
  v_mfma_f32_16x16x32_bf16 v[208:211], v[88:91], v[64:67], v[208:211]
  v_mfma_f32_16x16x32_bf16 v[212:215], v[88:91], v[68:71], v[212:215]
  v_mfma_f32_16x16x32_bf16 v[216:219], v[88:91], v[72:75], v[216:219]
  v_mfma_f32_16x16x32_bf16 v[220:223], v[88:91], v[76:79], v[220:223]
  v_mfma_f32_16x16x32_bf16 v[224:227], v[92:95], v[64:67], v[224:227]
  v_mfma_f32_16x16x32_bf16 v[228:231], v[92:95], v[68:71], v[228:231]
  v_mfma_f32_16x16x32_bf16 v[232:235], v[92:95], v[72:75], v[232:235]
  v_mfma_f32_16x16x32_bf16 v[236:239], v[92:95], v[76:79], v[236:239]
  v_mfma_f32_16x16x32_bf16 v[240:243], v[96:99], v[64:67], v[240:243]
  v_mfma_f32_16x16x32_bf16 v[244:247], v[96:99], v[68:71], v[244:247]
  v_mfma_f32_16x16x32_bf16 v[248:251], v[96:99], v[72:75], v[248:251]
  v_mfma_f32_16x16x32_bf16 v[252:255], v[96:99], v[76:79], v[252:255]
  s_waitcnt vmcnt(5)
  v_mfma_f32_16x16x32_bf16 v[176:179], v[100:103], v[16:19], v[176:179]
  v_mfma_f32_16x16x32_bf16 v[180:183], v[100:103], v[20:23], v[180:183]
  v_mfma_f32_16x16x32_bf16 v[184:187], v[100:103], v[24:27], v[184:187]
  v_mfma_f32_16x16x32_bf16 v[188:191], v[100:103], v[28:31], v[188:191]
  v_mfma_f32_16x16x32_bf16 v[192:195], v[104:107], v[16:19], v[192:195]
  v_mfma_f32_16x16x32_bf16 v[196:199], v[104:107], v[20:23], v[196:199]
  v_mfma_f32_16x16x32_bf16 v[200:203], v[104:107], v[24:27], v[200:203]
  v_mfma_f32_16x16x32_bf16 v[204:207], v[104:107], v[28:31], v[204:207]
  v_mfma_f32_16x16x32_bf16 v[208:211], v[108:111], v[16:19], v[208:211]
  v_mfma_f32_16x16x32_bf16 v[212:215], v[108:111], v[20:23], v[212:215]
  v_mfma_f32_16x16x32_bf16 v[216:219], v[108:111], v[24:27], v[216:219]
  v_mfma_f32_16x16x32_bf16 v[220:223], v[108:111], v[28:31], v[220:223]
  v_mfma_f32_16x16x32_bf16 v[224:227], v[112:115], v[16:19], v[224:227]
  v_mfma_f32_16x16x32_bf16 v[228:231], v[112:115], v[20:23], v[228:231]
  v_mfma_f32_16x16x32_bf16 v[232:235], v[112:115], v[24:27], v[232:235]
  v_mfma_f32_16x16x32_bf16 v[236:239], v[112:115], v[28:31], v[236:239]
  v_mfma_f32_16x16x32_bf16 v[240:243], v[116:119], v[16:19], v[240:243]
  v_mfma_f32_16x16x32_bf16 v[244:247], v[116:119], v[20:23], v[244:247]
  v_mfma_f32_16x16x32_bf16 v[248:251], v[116:119], v[24:27], v[248:251]
  v_mfma_f32_16x16x32_bf16 v[252:255], v[116:119], v[28:31], v[252:255]
  s_waitcnt vmcnt(0)
  v_mfma_f32_16x16x32_bf16 v[176:179], v[120:123], v[32:35], v[176:179]
  v_mfma_f32_16x16x32_bf16 v[180:183], v[120:123], v[36:39], v[180:183]
  v_mfma_f32_16x16x32_bf16 v[184:187], v[120:123], v[40:43], v[184:187]
  v_mfma_f32_16x16x32_bf16 v[188:191], v[120:123], v[44:47], v[188:191]
  v_mfma_f32_16x16x32_bf16 v[192:195], v[124:127], v[32:35], v[192:195]
  v_mfma_f32_16x16x32_bf16 v[196:199], v[124:127], v[36:39], v[196:199]
  v_mfma_f32_16x16x32_bf16 v[200:203], v[124:127], v[40:43], v[200:203]
  v_mfma_f32_16x16x32_bf16 v[204:207], v[124:127], v[44:47], v[204:207]
  v_mfma_f32_16x16x32_bf16 v[208:211], v[128:131], v[32:35], v[208:211]
  v_mfma_f32_16x16x32_bf16 v[212:215], v[128:131], v[36:39], v[212:215]
  v_mfma_f32_16x16x32_bf16 v[216:219], v[128:131], v[40:43], v[216:219]
  v_mfma_f32_16x16x32_bf16 v[220:223], v[128:131], v[44:47], v[220:223]
  v_mfma_f32_16x16x32_bf16 v[224:227], v[132:135], v[32:35], v[224:227]
  v_mfma_f32_16x16x32_bf16 v[228:231], v[132:135], v[36:39], v[228:231]
  v_mfma_f32_16x16x32_bf16 v[232:235], v[132:135], v[40:43], v[232:235]
  v_mfma_f32_16x16x32_bf16 v[236:239], v[132:135], v[44:47], v[236:239]
  v_mfma_f32_16x16x32_bf16 v[240:243], v[136:139], v[32:35], v[240:243]
  v_mfma_f32_16x16x32_bf16 v[244:247], v[136:139], v[36:39], v[244:247]
  v_mfma_f32_16x16x32_bf16 v[248:251], v[136:139], v[40:43], v[248:251]
  v_mfma_f32_16x16x32_bf16 v[252:255], v[136:139], v[44:47], v[252:255]
  buffer_load_dwordx2 v[120:121], v13, s[24:27], s62 offen offset:0
  buffer_load_dwordx2 v[122:123], v13, s[24:27], s62 offen offset:32
  buffer_load_dwordx2 v[124:125], v13, s[24:27], s62 offen offset:64
  buffer_load_dwordx2 v[126:127], v13, s[24:27], s62 offen offset:96
  buffer_load_dwordx2 v[128:129], v13, s[24:27], s62 offen offset:128
  s_xor_b32 s50, s52, 1
  s_lshl_b32 s51, s50, 2
  s_add_u32 s51, s51, s52
  s_mul_i32 s51, s51, 5120
  s_add_u32 s51, s51, 81920
  v_add_u32 v8, s51, v6
  s_lshl_b32 s51, s52, 2
  s_add_u32 s51, s51, s50
  s_mul_i32 s51, s51, 5120
  s_add_u32 s51, s51, 81920
  v_add_u32 v11, s51, v6
  s_xor_b32 s50, s52, 2
  s_lshl_b32 s51, s50, 2
  s_add_u32 s51, s51, s52
  s_mul_i32 s51, s51, 5120
  s_add_u32 s51, s51, 81920
  v_add_u32 v9, s51, v6
  s_lshl_b32 s51, s52, 2
  s_add_u32 s51, s51, s50
  s_mul_i32 s51, s51, 5120
  s_add_u32 s51, s51, 81920
  v_add_u32 v12, s51, v6
  s_xor_b32 s50, s52, 3
  s_lshl_b32 s51, s50, 2
  s_add_u32 s51, s51, s52
  s_mul_i32 s51, s51, 5120
  s_add_u32 s51, s51, 81920
  v_add_u32 v10, s51, v6
  s_lshl_b32 s51, s52, 2
  s_add_u32 s51, s51, s50
  s_mul_i32 s51, s51, 5120
  s_add_u32 s51, s51, 81920
  v_add_u32 v14, s51, v6
  ds_write_b128 v8, v[180:183] offset:0
  ds_write_b128 v8, v[196:199] offset:1024
  ds_write_b128 v8, v[212:215] offset:2048
  ds_write_b128 v8, v[228:231] offset:3072
  ds_write_b128 v8, v[244:247] offset:4096
  ds_write_b128 v9, v[184:187] offset:0
  ds_write_b128 v9, v[200:203] offset:1024
  ds_write_b128 v9, v[216:219] offset:2048
  ds_write_b128 v9, v[232:235] offset:3072
  ds_write_b128 v9, v[248:251] offset:4096
  ds_write_b128 v10, v[188:191] offset:0
  ds_write_b128 v10, v[204:207] offset:1024
  ds_write_b128 v10, v[220:223] offset:2048
  ds_write_b128 v10, v[236:239] offset:3072
  ds_write_b128 v10, v[252:255] offset:4096
  s_waitcnt lgkmcnt(0)
  s_barrier
  ds_read_b128 v[16:19], v11 offset:0
  ds_read_b128 v[20:23], v12 offset:0
  ds_read_b128 v[24:27], v14 offset:0
  ds_read_b128 v[28:31], v11 offset:1024
  ds_read_b128 v[32:35], v12 offset:1024
  ds_read_b128 v[36:39], v14 offset:1024
  ds_read_b128 v[40:43], v11 offset:2048
  ds_read_b128 v[44:47], v12 offset:2048
  ds_read_b128 v[48:51], v14 offset:2048
  ds_read_b128 v[52:55], v11 offset:3072
  ds_read_b128 v[56:59], v12 offset:3072
  ds_read_b128 v[60:63], v14 offset:3072
  ds_read_b128 v[64:67], v11 offset:4096
  ds_read_b128 v[68:71], v12 offset:4096
  ds_read_b128 v[72:75], v14 offset:4096
  s_waitcnt vmcnt(0)
  s_waitcnt lgkmcnt(12)
  v_pk_add_f32 v[16:17], v[16:17], v[20:21]
  v_pk_add_f32 v[18:19], v[18:19], v[22:23]
  v_pk_add_f32 v[24:25], v[24:25], v[176:177]
  v_pk_add_f32 v[26:27], v[26:27], v[178:179]
  v_lshlrev_b32 v100, 16, v120
  v_and_b32 v101, 0xffff0000, v120
  v_lshlrev_b32 v102, 16, v121
  v_and_b32 v103, 0xffff0000, v121
  v_pk_add_f32 v[16:17], v[16:17], v[24:25]
  v_pk_add_f32 v[18:19], v[18:19], v[26:27]
  v_pk_add_f32 v[16:17], v[16:17], v[100:101]
  v_pk_add_f32 v[18:19], v[18:19], v[102:103]
  v_cvt_pk_bf16_f32 v104, v16, v17
  v_cvt_pk_bf16_f32 v105, v18, v19
  buffer_store_dwordx2 v[104:105], v13, s[28:31], s62 offen offset:0
  s_waitcnt lgkmcnt(9)
  v_pk_add_f32 v[28:29], v[28:29], v[32:33]
  v_pk_add_f32 v[30:31], v[30:31], v[34:35]
  v_pk_add_f32 v[36:37], v[36:37], v[192:193]
  v_pk_add_f32 v[38:39], v[38:39], v[194:195]
  v_lshlrev_b32 v100, 16, v122
  v_and_b32 v101, 0xffff0000, v122
  v_lshlrev_b32 v102, 16, v123
  v_and_b32 v103, 0xffff0000, v123
  v_pk_add_f32 v[28:29], v[28:29], v[36:37]
  v_pk_add_f32 v[30:31], v[30:31], v[38:39]
  v_pk_add_f32 v[28:29], v[28:29], v[100:101]
  v_pk_add_f32 v[30:31], v[30:31], v[102:103]
  v_cvt_pk_bf16_f32 v106, v28, v29
  v_cvt_pk_bf16_f32 v107, v30, v31
  buffer_store_dwordx2 v[106:107], v13, s[28:31], s62 offen offset:32
  s_waitcnt lgkmcnt(6)
  v_pk_add_f32 v[40:41], v[40:41], v[44:45]
  v_pk_add_f32 v[42:43], v[42:43], v[46:47]
  v_pk_add_f32 v[48:49], v[48:49], v[208:209]
  v_pk_add_f32 v[50:51], v[50:51], v[210:211]
  v_lshlrev_b32 v100, 16, v124
  v_and_b32 v101, 0xffff0000, v124
  v_lshlrev_b32 v102, 16, v125
  v_and_b32 v103, 0xffff0000, v125
  v_pk_add_f32 v[40:41], v[40:41], v[48:49]
  v_pk_add_f32 v[42:43], v[42:43], v[50:51]
  v_pk_add_f32 v[40:41], v[40:41], v[100:101]
  v_pk_add_f32 v[42:43], v[42:43], v[102:103]
  v_cvt_pk_bf16_f32 v108, v40, v41
  v_cvt_pk_bf16_f32 v109, v42, v43
  buffer_store_dwordx2 v[108:109], v13, s[28:31], s62 offen offset:64
  s_waitcnt lgkmcnt(3)
  v_pk_add_f32 v[52:53], v[52:53], v[56:57]
  v_pk_add_f32 v[54:55], v[54:55], v[58:59]
  v_pk_add_f32 v[60:61], v[60:61], v[224:225]
  v_pk_add_f32 v[62:63], v[62:63], v[226:227]
  v_lshlrev_b32 v100, 16, v126
  v_and_b32 v101, 0xffff0000, v126
  v_lshlrev_b32 v102, 16, v127
  v_and_b32 v103, 0xffff0000, v127
  v_pk_add_f32 v[52:53], v[52:53], v[60:61]
  v_pk_add_f32 v[54:55], v[54:55], v[62:63]
  v_pk_add_f32 v[52:53], v[52:53], v[100:101]
  v_pk_add_f32 v[54:55], v[54:55], v[102:103]
  v_cvt_pk_bf16_f32 v110, v52, v53
  v_cvt_pk_bf16_f32 v111, v54, v55
  buffer_store_dwordx2 v[110:111], v13, s[28:31], s62 offen offset:96
  s_waitcnt lgkmcnt(0)
  v_pk_add_f32 v[64:65], v[64:65], v[68:69]
  v_pk_add_f32 v[66:67], v[66:67], v[70:71]
  v_pk_add_f32 v[72:73], v[72:73], v[240:241]
  v_pk_add_f32 v[74:75], v[74:75], v[242:243]
  v_lshlrev_b32 v100, 16, v128
  v_and_b32 v101, 0xffff0000, v128
  v_lshlrev_b32 v102, 16, v129
  v_and_b32 v103, 0xffff0000, v129
  v_pk_add_f32 v[64:65], v[64:65], v[72:73]
  v_pk_add_f32 v[66:67], v[66:67], v[74:75]
  v_pk_add_f32 v[64:65], v[64:65], v[100:101]
  v_pk_add_f32 v[66:67], v[66:67], v[102:103]
  v_cvt_pk_bf16_f32 v112, v64, v65
  v_cvt_pk_bf16_f32 v113, v66, v67
  buffer_store_dwordx2 v[112:113], v13, s[28:31], s62 offen offset:128
  s_endpgm
L_parallel_sum__spectral_fnet__dense_activation_relu__prompt_kernel_end:
  s_endpgm
.section .rodata,"a"
.p2align 6
.amdhsa_kernel parallel_sum__spectral_fnet__dense_activation_relu__prompt_kernel
  .amdhsa_next_free_vgpr 256
  .amdhsa_next_free_sgpr 102
  .amdhsa_accum_offset 256
  .amdhsa_group_segment_fixed_size 0
  .amdhsa_kernarg_size 88
  .amdhsa_user_sgpr_count 2
  .amdhsa_user_sgpr_kernarg_segment_ptr 1
  .amdhsa_system_sgpr_workgroup_id_x 1
.end_amdhsa_kernel
```
